```python
import torch

def _softmax(x, axis=-1):
    return torch.softmax(x, dim=axis)
def _gelu(x):
    return torch.nn.functional.gelu(x, approximate="tanh")
def _silu(x):
    return torch.nn.functional.silu(x)
def _sigmoid(x):
    return torch.sigmoid(x)
def _layernorm(x, axis=-1, eps=1e-5):
    m = x.mean(dim=axis, keepdim=True)
    v = x.var(dim=axis, keepdim=True, unbiased=False)
    return (x - m) / torch.sqrt(v + eps)
def _scatter_add(tgt, idx, src, axis=0):
    return tgt.clone().index_add_(axis, idx, src)
def _segment_sum(src, seg, n):
    out = torch.zeros((n,) + src.shape[1:], dtype=src.dtype)
    return out.index_add_(0, seg, src)
def _pad(x, pw):
    flat = tuple(v for pair in reversed(pw) for v in pair)
    return torch.nn.functional.pad(x, flat)

kernel_name = 'interleave_layers__sliding_block_cached__dense_activation_mish__decode'

def setup_inputs():

    _w = (lambda a: (lambda t: t.to(torch.bfloat16) if t.is_floating_point() else t)(torch.as_tensor(a)))
    def _A_setup():
        B, Sq, D = 8, 1, 512
        Hq, Hkv, Sk, Dh = 32, 8, 4096, 128
        assert Hq % Hkv == 0, (Hq, Hkv)
        return {
            "x": _w((lambda *s: torch.randn(*s, dtype=torch.bfloat16) * 0.05)(B, Sq, D)),
            "k_cache": _w((lambda *s: torch.randn(*s, dtype=torch.bfloat16) * 0.8)(B, Hkv, Sk, Dh)),
            "v_cache": _w((lambda *s: torch.randn(*s, dtype=torch.bfloat16) * 1.6)(B, Hkv, Sk, Dh)),
            "wq": _w((lambda *s: torch.randn(*s, dtype=torch.bfloat16) * 0.8)(D, Hq * Dh) * (D ** -0.5)),
            "wo": _w((lambda *s: torch.randn(*s, dtype=torch.bfloat16) * 1.6)(Hq * Dh, D) * ((Hq * Dh) ** -0.5)),
        }
    _A_in = _A_setup()

    def _B_setup():
        B, S, D, F = 8, 1, 512, 1792
        return {
            "x": _w((lambda *s: torch.randn(*s, dtype=torch.bfloat16) * 0.05)(B, S, D)),
            "w1": _w((lambda *s: torch.randn(*s, dtype=torch.bfloat16) * 1.6)(D, F) * (D ** -0.5)),
            "b1": _w((lambda *s: torch.randn(*s, dtype=torch.bfloat16) * 0.4)(F)),
            "w2": _w((lambda *s: torch.randn(*s, dtype=torch.bfloat16) * 0.2)(F, D) * (F ** -0.5)),
        }
    _B_in = _B_setup()

    return {
        "A_x": _A_in["x"],
        "A_k_cache": _A_in["k_cache"],
        "A_v_cache": _A_in["v_cache"],
        "A_wq": _A_in["wq"],
        "A_wo": _A_in["wo"],
        "B_x": _B_in["x"],
        "B_w1": _B_in["w1"],
        "B_b1": _B_in["b1"],
        "B_w2": _B_in["w2"],
    }

def reference(A_x, A_k_cache, A_v_cache, A_wq, A_wo, B_x, B_w1, B_b1, B_w2):
    def _A_ref(x, k_cache, v_cache, wq, wo):
        B, Sq, D = x.shape
        Hq, Dh = 32, 128
        Hkv, Sk = k_cache.shape[1], k_cache.shape[2]
        W = min(4096, max(256, Sk // 4))
        rep = Hq // Hkv
        q = (lambda x, *d: x.permute(*d))((x @ wq).reshape(B, Sq, Hq, Dh), 0, 2, 1, 3)
        k = (lambda x, n, axis: torch.repeat_interleave(x, n, dim=axis))(k_cache[:, :, Sk - W:, :], rep, axis=1)
        v = (lambda x, n, axis: torch.repeat_interleave(x, n, dim=axis))(v_cache[:, :, Sk - W:, :], rep, axis=1)
        scores = torch.einsum("bhqd,bhkd->bhqk", q, k) * (Dh ** -0.5)
        p = _softmax(scores, axis=-1)
        o = torch.einsum("bhqk,bhkd->bhqd", p, v)
        return (lambda x, *d: x.permute(*d))(o, 0, 2, 1, 3).reshape(B, Sq, Hq * Dh) @ wo

    def _B_ref(x, w1, b1, w2):
        h = torch.einsum("bsd,df->bsf", x, w1) + b1
        sp = torch.log1p(torch.exp(-torch.abs(h))) + torch.where(h > 0, h, torch.zeros_like(h))
        act = h * torch.tanh(sp)
        return torch.einsum("bsf,fd->bsd", act, w2)

    x = A_x
    x = x + _A_ref(_layernorm(x, axis=-1), A_k_cache, A_v_cache, A_wq, A_wo)
    x = x + _B_ref(_layernorm(x, axis=-1), B_w1, B_b1, B_w2)
    x = x + _A_ref(_layernorm(x, axis=-1), A_k_cache, A_v_cache, A_wq, A_wo)
    x = x + _B_ref(_layernorm(x, axis=-1), B_w1, B_b1, B_w2)
    return x
```

```asm
; @launch grid=(256,1,1) block=(512,1,1) lds=77824
.amdgcn_target "amdgcn-amd-amdhsa--gfx950"
.text
.globl interleave_layers__sliding_block_cached__dense_activation_mish__decode_kernel
.p2align 8
.type interleave_layers__sliding_block_cached__dense_activation_mish__decode_kernel,@function
interleave_layers__sliding_block_cached__dense_activation_mish__decode_kernel:
  s_cmp_ge_u32 s2, 256
  s_cbranch_scc1 L_end
  s_load_dwordx16 s[64:79], s[0:1], 0
  s_load_dwordx8 s[80:87], s[0:1], 64
  v_lshrrev_b32 v1, 6, v0
  v_and_b32 v0, 63, v0
  s_and_b32 s52, s2, 7
  s_lshr_b32 s53, s2, 3
  v_readfirstlane_b32 s54, v1
  v_mov_b32 v2, 0
  v_lshlrev_b32 v3, 2, v0
  v_add_u32 v3, 10496, v3
  s_and_b32 s88, s53, 3
  s_lshr_b32 s89, s53, 2
  v_and_b32 v4, 15, v0
  v_lshrrev_b32 v5, 4, v0
  s_cmp_lg_u32 s54, 0
  s_cbranch_scc1 L_nz
  ds_write_b32 v3, v2
L_nz:
  s_mov_b32 s55, 0
  s_mov_b32 s56, 2
  s_mov_b32 s61, 3149824
  s_mul_i32 s3, s52, 163840
  s_and_b32 s60, s54, 3
  s_waitcnt lgkmcnt(0)
  s_mov_b32 s48, s86
  s_mov_b32 s49, s87
  s_mov_b32 s50, 268435456
  s_mov_b32 s51, 0x20000
  s_cmp_lt_u32 s54, 4
  s_cbranch_scc1 L_A
L_early:
  s_setprio 3
  s_load_dword s62, s[86:87], s61
  s_mov_b32 s16, s70
  s_mov_b32 s17, s71
  s_mov_b32 s18, 4194304
  s_mov_b32 s19, 0x20000
  s_mov_b32 s20, s64
  s_mov_b32 s21, s65
  s_mov_b32 s22, 8192
  s_mov_b32 s23, 0x20000
  v_lshlrev_b32 v8, 4, v0
  s_lshl_b32 s92, s60, 11
  s_add_u32 s93, s92, 69632
  s_mov_b32 m0, s93
  v_lshrrev_b32 v9, 3, v0
  buffer_load_dwordx4 v8, s[20:23], s92 offen  lds
  s_add_u32 s93, s93, 1024
  s_add_u32 s92, s92, 1024
  s_mov_b32 m0, s93
  v_lshlrev_b32 v9, 13, v9
  buffer_load_dwordx4 v8, s[20:23], s92 offen  lds
  v_and_b32 v10, 7, v0
  v_lshlrev_b32 v10, 4, v10
  v_add_u32 v9, v9, v10
  s_lshl_b32 s92, s88, 20
  s_lshl_b32 s93, s60, 18
  s_add_u32 s92, s92, s93
  s_lshl_b32 s93, s52, 10
  s_add_u32 s92, s92, s93
  s_lshl_b32 s93, s89, 7
  s_add_u32 s92, s92, s93
  s_lshl_b32 s93, s60, 12
  s_add_u32 s93, s93, 12288
  s_mov_b32 m0, s93
  s_nop 0
  buffer_load_dwordx4 v9, s[16:19], s92 offen nt lds
  s_add_u32 s92, s92, 65536
  s_add_u32 s93, s93, 1024
  s_mov_b32 m0, s93
  s_nop 0
  buffer_load_dwordx4 v9, s[16:19], s92 offen nt lds
  s_add_u32 s92, s92, 65536
  s_add_u32 s93, s93, 1024
  s_mov_b32 m0, s93
  s_nop 0
  buffer_load_dwordx4 v9, s[16:19], s92 offen nt lds
  s_add_u32 s92, s92, 65536
  s_add_u32 s93, s93, 1024
  s_mov_b32 m0, s93
  s_nop 0
  buffer_load_dwordx4 v9, s[16:19], s92 offen nt lds
  s_add_u32 s92, s92, 65536
  s_add_u32 s93, s93, 1024
  v_mov_b32 v12, -1
  v_mov_b32 v13, -1
  v_mov_b32 v14, -1
  v_mov_b32 v15, -1
  s_mul_i32 s90, s53, 5120
  s_add_u32 s90, s90, s3
  s_lshl_b32 s91, s60, 10
  s_add_u32 s90, s90, s91
  buffer_store_dwordx4 v[12:15], v8, s[48:51], s90 offen
  s_add_u32 s90, s90, 4096
  s_cmp_lg_u32 s60, 0
  s_cselect_b32 s90, 0x20000000, s90
  buffer_store_dwordx4 v[12:15], v8, s[48:51], s90 offen
  s_lshl_b32 s92, s60, 18
  s_add_u32 s92, s92, 1310720
  s_cmp_ge_u32 s60, 2
  s_cbranch_scc1 L_early_pf
  s_lshl_b32 s93, s89, 15
  s_add_u32 s92, s92, s93
  s_lshl_b32 s93, s52, 2
  s_add_u32 s93, s93, s88
  s_lshl_b32 s93, s93, 8
  s_add_u32 s92, s92, s93
  v_lshlrev_b32 v10, 13, v5
  s_branch L_early_pfd
L_early_pf:
  s_lshr_b32 s93, s53, 1
  s_lshl_b32 s93, s93, 13
  s_add_u32 s92, s92, s93
  s_lshl_b32 s93, s52, 1
  s_and_b32 s91, s53, 1
  s_add_u32 s93, s93, s91
  s_lshl_b32 s93, s93, 8
  s_add_u32 s92, s92, s93
  v_and_b32 v10, 1, v5
  v_lshlrev_b32 v10, 12, v10
L_early_pfd:
  v_lshlrev_b32 v11, 4, v4
  v_add_u32 v10, v10, v11
  buffer_store_dwordx4 v[12:15], v10, s[48:51], s92 offen sc1
  s_and_b32 s93, s60, 1
  s_lshl_b32 s93, s93, 7
  s_lshl_b32 s92, s89, 8
  s_add_u32 s92, s92, s93
  s_mul_i32 s93, s88, 0x5000
  s_add_u32 s92, s92, s93
  s_mul_i32 s93, s52, 0x14000
  s_add_u32 s92, s92, s93
  s_add_u32 s92, s92, 3211264
  v_and_b32 v10, 7, v0
  v_lshlrev_b32 v10, 11, v10
  v_bfe_u32 v11, v0, 3, 1
  v_lshlrev_b32 v11, 6, v11
  v_add_u32 v10, v10, v11
  v_lshlrev_b32 v11, 4, v5
  v_add_u32 v10, v10, v11
  s_cmp_lt_u32 s60, 2
  s_cbranch_scc1 L_early3
  v_and_b32 v10, 0x7f, v10
  s_add_u32 s92, s92, 16384
L_early3:
  buffer_store_dwordx4 v[12:15], v10, s[48:51], s92 offen
  s_barrier
  s_setprio 0
  s_waitcnt vmcnt(4)
  v_mov_b32 v1, 10496
  v_mov_b32 v2, 1
  s_mov_b64 exec, 1
  ds_add_u32 v1, v2
  s_mov_b64 exec, -1
  s_waitcnt vmcnt(0)
  v_mov_b32 v1, 10532
  v_mov_b32 v2, 1
  s_mov_b64 exec, 1
  ds_add_u32 v1, v2
  s_mov_b64 exec, -1
  v_and_b32 v6, 7, v4
  v_lshrrev_b32 v7, 3, v4
  s_mov_b32 s100, 0xff00ff00
  s_mov_b32 s101, 0xff00ff00
  s_waitcnt lgkmcnt(0)
  s_add_u32 s63, s62, 1
  s_and_b32 s63, s63, 0x7fffffff
  s_cmp_lt_u32 s60, 2
  s_cbranch_scc1 L_C
  s_cmp_eq_u32 s60, 3
  s_cbranch_scc1 L_P
  s_branch L_H
L_A:
  s_mov_b32 s8, s66
  s_mov_b32 s9, s67
  s_mov_b32 s10, 67108864
  s_mov_b32 s11, 0x20000
  s_lshl_b32 s90, s89, 3
  s_add_u32 s90, s90, s52
  s_lshl_b32 s90, s90, 12
  s_lshl_b32 s91, s88, 8
  s_add_u32 s90, s90, s91
  s_lshl_b32 s91, s60, 6
  s_add_u32 s90, s90, s91
  s_add_u32 s90, s90, 3072
  s_lshl_b32 s90, s90, 8
  s_add_u32 s91, s90, 4096
  s_add_u32 s92, s90, 8192
  s_add_u32 s93, s90, 12288
  v_lshlrev_b32 v8, 8, v4
  v_lshlrev_b32 v9, 4, v5
  v_add_u32 v8, v8, v9
  s_barrier
  buffer_load_dwordx4 v[64:67], v8, s[8:11], s90 offen offset:0 nt
  buffer_load_dwordx4 v[68:71], v8, s[8:11], s90 offen offset:64 nt
  buffer_load_dwordx4 v[72:75], v8, s[8:11], s90 offen offset:128 nt
  buffer_load_dwordx4 v[76:79], v8, s[8:11], s90 offen offset:192 nt
  buffer_load_dwordx4 v[80:83], v8, s[8:11], s91 offen offset:0 nt
  buffer_load_dwordx4 v[84:87], v8, s[8:11], s91 offen offset:64 nt
  s_waitcnt vmcnt(5)
  buffer_load_dwordx4 v[88:91], v8, s[8:11], s91 offen offset:128 nt
  s_waitcnt vmcnt(5)
  buffer_load_dwordx4 v[92:95], v8, s[8:11], s91 offen offset:192 nt
  s_waitcnt vmcnt(5)
  buffer_load_dwordx4 v[96:99], v8, s[8:11], s92 offen offset:0 nt
  s_waitcnt vmcnt(5)
  buffer_load_dwordx4 v[100:103], v8, s[8:11], s92 offen offset:64 nt
  s_waitcnt vmcnt(5)
  buffer_load_dwordx4 v[104:107], v8, s[8:11], s92 offen offset:128 nt
  s_waitcnt vmcnt(5)
  buffer_load_dwordx4 v[108:111], v8, s[8:11], s92 offen offset:192 nt
  s_waitcnt vmcnt(5)
  buffer_load_dwordx4 v[112:115], v8, s[8:11], s93 offen offset:0 nt
  s_waitcnt vmcnt(5)
  buffer_load_dwordx4 v[116:119], v8, s[8:11], s93 offen offset:64 nt
  s_waitcnt vmcnt(5)
  buffer_load_dwordx4 v[120:123], v8, s[8:11], s93 offen offset:128 nt
  s_waitcnt vmcnt(5)
  buffer_load_dwordx4 v[124:127], v8, s[8:11], s93 offen offset:192 nt
  s_mov_b32 s12, s68
  s_mov_b32 s13, s69
  s_mov_b32 s14, 67108864
  s_mov_b32 s15, 0x20000
  v_lshlrev_b32 v9, 10, v5
  v_lshlrev_b32 v10, 4, v4
  v_add_u32 v9, v9, v10
  s_waitcnt vmcnt(5)
  buffer_load_dwordx4 v[192:195], v9, s[12:15], s90 offen offset:0 nt
  s_waitcnt vmcnt(5)
  buffer_load_dwordx4 v[196:199], v9, s[12:15], s90 offen offset:256 nt
  s_waitcnt vmcnt(5)
  buffer_load_dwordx4 v[200:203], v9, s[12:15], s90 offen offset:512 nt
  s_waitcnt vmcnt(5)
  buffer_load_dwordx4 v[204:207], v9, s[12:15], s90 offen offset:768 nt
  s_waitcnt vmcnt(5)
  buffer_load_dwordx4 v[208:211], v9, s[12:15], s91 offen offset:0 nt
  s_waitcnt vmcnt(5)
  buffer_load_dwordx4 v[212:215], v9, s[12:15], s91 offen offset:256 nt
  s_waitcnt vmcnt(5)
  buffer_load_dwordx4 v[216:219], v9, s[12:15], s91 offen offset:512 nt
  s_waitcnt vmcnt(5)
  buffer_load_dwordx4 v[220:223], v9, s[12:15], s91 offen offset:768 nt
  buffer_load_dwordx4 v[224:227], v9, s[12:15], s92 offen offset:0 nt
  buffer_load_dwordx4 v[228:231], v9, s[12:15], s92 offen offset:256 nt
  buffer_load_dwordx4 v[232:235], v9, s[12:15], s92 offen offset:512 nt
  buffer_load_dwordx4 v[236:239], v9, s[12:15], s92 offen offset:768 nt
  buffer_load_dwordx4 v[240:243], v9, s[12:15], s93 offen offset:0 nt
  buffer_load_dwordx4 v[244:247], v9, s[12:15], s93 offen offset:256 nt
  buffer_load_dwordx4 v[248:251], v9, s[12:15], s93 offen offset:512 nt
  buffer_load_dwordx4 v[252:255], v9, s[12:15], s93 offen offset:768 nt
  v_mov_b32 v1, 10548
  v_mov_b32 v2, 1
  s_mov_b64 exec, 1
  ds_add_u32 v1, v2
  s_mov_b64 exec, -1
  s_load_dword s62, s[86:87], s61
  v_and_b32 v14, 3, v4
  v_lshlrev_b32 v9, 8, v14
  v_lshlrev_b32 v13, 4, v5
  v_add_u32 v9, v9, v13
  v_add_u32 v9, 9216, v9
  v_lshlrev_b32 v10, 4, v0
  s_lshl_b32 s94, s60, 11
  v_add_u32 v10, s94, v10
  v_lshlrev_b32 v11, 4, v14
  s_lshl_b32 s94, s60, 2
  s_add_u32 s94, s94, 10240
  v_add_u32 v11, s94, v11
  s_lshl_b32 s94, s60, 4
  s_add_u32 s94, s94, 10304
  v_mov_b32 v62, s94
  v_lshrrev_b32 v12, 2, v0
  v_lshlrev_b32 v12, 4, v12
  v_and_b32 v14, 2, v0
  v_lshlrev_b32 v14, 9, v14
  v_add_u32 v12, v12, v14
  v_and_b32 v14, 1, v0
  v_lshlrev_b32 v14, 9, v14
  v_add_u32 v12, v12, v14
  s_lshl_b32 s94, s60, 2
  v_add_u32 v12, s94, v12
  s_lshl_b32 s94, s60, 4
  s_add_u32 s94, s94, 10240
  v_mov_b32 v15, s94
  s_lshl_b32 s94, s60, 2
  s_add_u32 s94, s94, 10304
  v_mov_b32 v63, s94
  s_lshl_b32 s95, s60, 13
  s_add_u32 s94, s3, s95
  s_lshr_b32 s95, s88, 1
  s_lshl_b32 s95, s95, 12
  s_add_u32 s94, s94, s95
  s_and_b32 s95, s88, 1
  s_lshl_b32 s95, s95, 7
  s_add_u32 s94, s94, s95
  s_lshl_b32 s95, s89, 4
  s_add_u32 s94, s94, s95
  s_add_u32 s94, s94, 65536
  v_lshrrev_b32 v13, 4, v0
  v_lshlrev_b32 v13, 10, v13
  v_bfe_u32 v14, v0, 2, 2
  v_lshlrev_b32 v14, 8, v14
  v_add_u32 v13, v13, v14
  v_and_b32 v14, 3, v0
  v_lshlrev_b32 v14, 2, v14
  v_add_u32 v13, v13, v14
  v_add_u32 v13, s94, v13
  s_lshl_b32 s95, s60, 8
  s_add_u32 s94, s3, s95
  s_lshr_b32 s95, s88, 1
  s_lshl_b32 s95, s95, 7
  s_add_u32 s94, s94, s95
  s_lshl_b32 s95, s89, 4
  s_add_u32 s94, s94, s95
  s_and_b32 s95, s88, 1
  s_lshl_b32 s95, s95, 3
  s_add_u32 s94, s94, s95
  s_add_u32 s96, s94, 131072
  s_lshl_b32 s94, s52, 2
  s_add_u32 s94, s94, s60
  s_lshl_b32 s94, s94, 7
  s_lshl_b32 s95, s53, 2
  s_add_u32 s94, s94, s95
  s_add_u32 s97, s94, 3162112
  v_mov_b32 v4, 0x3f803f80
  v_mov_b32 v5, 0x3f803f80
  v_mov_b32 v6, 0x3f803f80
  v_mov_b32 v7, 0x3f803f80
  s_mov_b32 s16, 0x000f000f
  s_mov_b32 s17, 0x000f000f
  s_mov_b32 s18, 0x00f000f0
  s_mov_b32 s19, 0x00f000f0
  s_mov_b32 s20, 0x0f000f00
  s_mov_b32 s21, 0x0f000f00
  s_mov_b32 s22, 0xf000f000
  s_mov_b32 s23, 0xf000f000
  s_mov_b32 s98, 0x05040100
  s_mov_b32 s99, 0x07060302
  s_waitcnt lgkmcnt(0)
  s_add_u32 s63, s62, 1
  s_and_b32 s63, s63, 0x7fffffff
  s_mov_b32 s58, 0
  v_mov_b32 v1, 10520
L_spaq_1:
  ds_read_b32 v2, v1
  s_add_u32 s58, s58, 1
  s_waitcnt lgkmcnt(0)
  v_readfirstlane_b32 s57, v2
  s_cmp_gt_u32 s58, 200000
  s_cbranch_scc1 L_spdaq_2
  s_cmp_lt_u32 s57, 2
  s_cbranch_scc1 L_spaq_1
L_spdaq_2:
  s_waitcnt vmcnt(16)
  s_branch L_A_go
L_A_loop:
  s_barrier
L_A_go:
  ds_read_b128 v[16:19], v9 offset:0
  ds_read_b128 v[20:23], v9 offset:64
  ds_read_b128 v[24:27], v9 offset:128
  ds_read_b128 v[28:31], v9 offset:192
  s_waitcnt lgkmcnt(3)
  v_mfma_f32_16x16x32_bf16 v[32:35], v[64:67], v[16:19], 0
  v_mfma_f32_16x16x32_bf16 v[36:39], v[80:83], v[16:19], 0
  v_mfma_f32_16x16x32_bf16 v[40:43], v[96:99], v[16:19], 0
  v_mfma_f32_16x16x32_bf16 v[44:47], v[112:115], v[16:19], 0
  s_waitcnt lgkmcnt(2)
  v_mfma_f32_16x16x32_bf16 v[32:35], v[68:71], v[20:23], v[32:35]
  v_mfma_f32_16x16x32_bf16 v[36:39], v[84:87], v[20:23], v[36:39]
  v_mfma_f32_16x16x32_bf16 v[40:43], v[100:103], v[20:23], v[40:43]
  v_mfma_f32_16x16x32_bf16 v[44:47], v[116:119], v[20:23], v[44:47]
  s_waitcnt lgkmcnt(1)
  v_mfma_f32_16x16x32_bf16 v[32:35], v[72:75], v[24:27], v[32:35]
  v_mfma_f32_16x16x32_bf16 v[36:39], v[88:91], v[24:27], v[36:39]
  v_mfma_f32_16x16x32_bf16 v[40:43], v[104:107], v[24:27], v[40:43]
  v_mfma_f32_16x16x32_bf16 v[44:47], v[120:123], v[24:27], v[44:47]
  s_waitcnt lgkmcnt(0)
  v_mfma_f32_16x16x32_bf16 v[32:35], v[76:79], v[28:31], v[32:35]
  v_mfma_f32_16x16x32_bf16 v[36:39], v[92:95], v[28:31], v[36:39]
  v_mfma_f32_16x16x32_bf16 v[40:43], v[108:111], v[28:31], v[40:43]
  v_mfma_f32_16x16x32_bf16 v[44:47], v[124:127], v[28:31], v[44:47]
  s_nop 4
  v_max3_f32 v56, v32, v33, v34
  v_max3_f32 v58, v36, v37, v38
  v_max3_f32 v59, v40, v41, v42
  v_max3_f32 v57, v44, v45, v46
  v_max3_f32 v56, v56, v35, v39
  v_max3_f32 v57, v57, v43, v47
  v_max3_f32 v56, v56, v58, v59
  v_max_f32 v56, v56, v57
  v_mov_b32 v57, v56
  s_nop 1
  v_permlane16_swap_b32 v56, v57
  v_max_f32 v56, v56, v57
  v_mov_b32 v57, v56
  s_nop 1
  v_permlane32_swap_b32 v56, v57
  v_max_f32 v56, v56, v57
  v_pk_add_f32 v[32:33], v[32:33], v[56:57] op_sel_hi:[1,0] neg_lo:[0,1] neg_hi:[0,1]
  v_pk_add_f32 v[34:35], v[34:35], v[56:57] op_sel_hi:[1,0] neg_lo:[0,1] neg_hi:[0,1]
  v_pk_add_f32 v[36:37], v[36:37], v[56:57] op_sel_hi:[1,0] neg_lo:[0,1] neg_hi:[0,1]
  v_pk_add_f32 v[38:39], v[38:39], v[56:57] op_sel_hi:[1,0] neg_lo:[0,1] neg_hi:[0,1]
  v_pk_add_f32 v[40:41], v[40:41], v[56:57] op_sel_hi:[1,0] neg_lo:[0,1] neg_hi:[0,1]
  v_pk_add_f32 v[42:43], v[42:43], v[56:57] op_sel_hi:[1,0] neg_lo:[0,1] neg_hi:[0,1]
  v_pk_add_f32 v[44:45], v[44:45], v[56:57] op_sel_hi:[1,0] neg_lo:[0,1] neg_hi:[0,1]
  v_pk_add_f32 v[46:47], v[46:47], v[56:57] op_sel_hi:[1,0] neg_lo:[0,1] neg_hi:[0,1]
  v_exp_f32 v32, v32
  v_exp_f32 v33, v33
  v_exp_f32 v34, v34
  v_exp_f32 v35, v35
  v_cvt_pk_bf16_f32 v48, v32, v33
  v_exp_f32 v36, v36
  v_exp_f32 v37, v37
  v_cvt_pk_bf16_f32 v49, v34, v35
  v_exp_f32 v38, v38
  v_exp_f32 v39, v39
  v_cvt_pk_bf16_f32 v50, v36, v37
  v_cvt_pk_bf16_f32 v51, v38, v39
  s_cmp_lg_u32 s55, 0
  s_cbranch_scc1 L_A_not0
  s_waitcnt vmcnt(14)
  v_perm_b32 v128, v196, v192, s98
  v_perm_b32 v132, v196, v192, s99
  v_perm_b32 v136, v197, v193, s98
  v_perm_b32 v140, v197, v193, s99
  v_perm_b32 v144, v198, v194, s98
  v_perm_b32 v148, v198, v194, s99
  v_perm_b32 v152, v199, v195, s98
  v_perm_b32 v156, v199, v195, s99
  s_waitcnt vmcnt(12)
  v_perm_b32 v129, v204, v200, s98
  v_perm_b32 v133, v204, v200, s99
  v_perm_b32 v137, v205, v201, s98
  v_perm_b32 v141, v205, v201, s99
  v_perm_b32 v145, v206, v202, s98
  v_perm_b32 v149, v206, v202, s99
  v_perm_b32 v153, v207, v203, s98
  v_perm_b32 v157, v207, v203, s99
  s_waitcnt vmcnt(10)
  v_perm_b32 v130, v212, v208, s98
  v_perm_b32 v134, v212, v208, s99
  v_perm_b32 v138, v213, v209, s98
  v_perm_b32 v142, v213, v209, s99
  v_perm_b32 v146, v214, v210, s98
  v_perm_b32 v150, v214, v210, s99
  v_perm_b32 v154, v215, v211, s98
  v_perm_b32 v158, v215, v211, s99
  s_waitcnt vmcnt(8)
  v_perm_b32 v131, v220, v216, s98
  v_perm_b32 v135, v220, v216, s99
  v_perm_b32 v139, v221, v217, s98
  v_perm_b32 v143, v221, v217, s99
  v_perm_b32 v147, v222, v218, s98
  v_perm_b32 v151, v222, v218, s99
  v_perm_b32 v155, v223, v219, s98
  v_perm_b32 v159, v223, v219, s99
  s_nop 1
L_A_not0:
  v_cndmask_b32 v200, 0, v48, s[16:17]
  v_cndmask_b32 v201, 0, v49, s[16:17]
  v_cndmask_b32 v202, 0, v50, s[16:17]
  v_cndmask_b32 v203, 0, v51, s[16:17]
  v_cndmask_b32 v204, 0, v48, s[18:19]
  v_cndmask_b32 v205, 0, v49, s[18:19]
  v_mfma_f32_16x16x32_bf16 v[192:195], v[200:203], v[128:131], 0
  v_cndmask_b32 v206, 0, v50, s[18:19]
  v_cndmask_b32 v207, 0, v51, s[18:19]
  v_exp_f32 v40, v40
  v_mfma_f32_16x16x32_bf16 v[196:199], v[200:203], v[144:147], 0
  v_cndmask_b32 v208, 0, v48, s[20:21]
  v_cndmask_b32 v209, 0, v49, s[20:21]
  v_exp_f32 v41, v41
  v_mfma_f32_16x16x32_bf16 v[28:31], v[200:203], v[4:7], 0
  v_mfma_f32_16x16x32_bf16 v[192:195], v[204:207], v[132:135], v[192:195]
  v_cndmask_b32 v210, 0, v50, s[20:21]
  v_cndmask_b32 v211, 0, v51, s[20:21]
  v_exp_f32 v42, v42
  v_mfma_f32_16x16x32_bf16 v[196:199], v[204:207], v[148:151], v[196:199]
  v_cndmask_b32 v212, 0, v48, s[22:23]
  v_cndmask_b32 v213, 0, v49, s[22:23]
  v_exp_f32 v43, v43
  v_mfma_f32_16x16x32_bf16 v[192:195], v[208:211], v[136:139], v[192:195]
  v_cndmask_b32 v214, 0, v50, s[22:23]
  v_cndmask_b32 v215, 0, v51, s[22:23]
  v_exp_f32 v44, v44
  v_mfma_f32_16x16x32_bf16 v[196:199], v[208:211], v[152:155], v[196:199]
  v_exp_f32 v45, v45
  v_mfma_f32_16x16x32_bf16 v[192:195], v[212:215], v[140:143], v[192:195]
  v_exp_f32 v46, v46
  v_mfma_f32_16x16x32_bf16 v[196:199], v[212:215], v[156:159], v[196:199]
  v_exp_f32 v47, v47
  v_cvt_pk_bf16_f32 v52, v40, v41
  v_cvt_pk_bf16_f32 v53, v42, v43
  v_cvt_pk_bf16_f32 v54, v44, v45
  v_cvt_pk_bf16_f32 v55, v46, v47
  s_cmp_lg_u32 s55, 0
  s_cbranch_scc1 L_A_not1
  s_waitcnt vmcnt(6)
  v_perm_b32 v160, v228, v224, s98
  v_perm_b32 v164, v228, v224, s99
  v_perm_b32 v168, v229, v225, s98
  v_perm_b32 v172, v229, v225, s99
  v_perm_b32 v176, v230, v226, s98
  v_perm_b32 v180, v230, v226, s99
  v_perm_b32 v184, v231, v227, s98
  v_perm_b32 v188, v231, v227, s99
  s_waitcnt vmcnt(4)
  v_perm_b32 v161, v236, v232, s98
  v_perm_b32 v165, v236, v232, s99
  v_perm_b32 v169, v237, v233, s98
  v_perm_b32 v173, v237, v233, s99
  v_perm_b32 v177, v238, v234, s98
  v_perm_b32 v181, v238, v234, s99
  v_perm_b32 v185, v239, v235, s98
  v_perm_b32 v189, v239, v235, s99
  s_waitcnt vmcnt(2)
  v_perm_b32 v162, v244, v240, s98
  v_perm_b32 v166, v244, v240, s99
  v_perm_b32 v170, v245, v241, s98
  v_perm_b32 v174, v245, v241, s99
  v_perm_b32 v178, v246, v242, s98
  v_perm_b32 v182, v246, v242, s99
  v_perm_b32 v186, v247, v243, s98
  v_perm_b32 v190, v247, v243, s99
  s_waitcnt vmcnt(0)
  v_perm_b32 v163, v252, v248, s98
  v_perm_b32 v167, v252, v248, s99
  v_perm_b32 v171, v253, v249, s98
  v_perm_b32 v175, v253, v249, s99
  v_perm_b32 v179, v254, v250, s98
  v_perm_b32 v183, v254, v250, s99
  v_perm_b32 v187, v255, v251, s98
  v_perm_b32 v191, v255, v251, s99
  v_mov_b32 v1, 10516
  v_mov_b32 v2, 1
  s_mov_b64 exec, 1
  ds_add_u32 v1, v2
  s_mov_b64 exec, -1
  s_nop 1
L_A_not1:
  v_cndmask_b32 v200, 0, v52, s[16:17]
  v_cndmask_b32 v201, 0, v53, s[16:17]
  v_cndmask_b32 v202, 0, v54, s[16:17]
  v_cndmask_b32 v203, 0, v55, s[16:17]
  v_cndmask_b32 v204, 0, v52, s[18:19]
  v_cndmask_b32 v205, 0, v53, s[18:19]
  v_mfma_f32_16x16x32_bf16 v[192:195], v[200:203], v[160:163], v[192:195]
  v_cndmask_b32 v206, 0, v54, s[18:19]
  v_cndmask_b32 v207, 0, v55, s[18:19]
  v_mfma_f32_16x16x32_bf16 v[196:199], v[200:203], v[176:179], v[196:199]
  v_cndmask_b32 v208, 0, v52, s[20:21]
  v_cndmask_b32 v209, 0, v53, s[20:21]
  v_mfma_f32_16x16x32_bf16 v[28:31], v[200:203], v[4:7], v[28:31]
  v_mfma_f32_16x16x32_bf16 v[192:195], v[204:207], v[164:167], v[192:195]
  v_cndmask_b32 v210, 0, v54, s[20:21]
  v_cndmask_b32 v211, 0, v55, s[20:21]
  v_mfma_f32_16x16x32_bf16 v[196:199], v[204:207], v[180:183], v[196:199]
  v_cndmask_b32 v212, 0, v52, s[22:23]
  v_cndmask_b32 v213, 0, v53, s[22:23]
  v_mfma_f32_16x16x32_bf16 v[192:195], v[208:211], v[168:171], v[192:195]
  v_cndmask_b32 v214, 0, v54, s[22:23]
  v_cndmask_b32 v215, 0, v55, s[22:23]
  v_mfma_f32_16x16x32_bf16 v[196:199], v[208:211], v[184:187], v[196:199]
  s_nop 0
  v_mfma_f32_16x16x32_bf16 v[192:195], v[212:215], v[172:175], v[192:195]
  v_mfma_f32_16x16x32_bf16 v[196:199], v[212:215], v[188:191], v[196:199]
  s_mov_b64 exec, 15
  ds_write_b32 v11, v56
  s_mov_b64 exec, 1
  ds_write_b128 v62, v[28:31]
  s_mov_b64 exec, -1
  s_nop 1
  ds_write_b128 v10, v[192:195]
  ds_write_b128 v10, v[196:199] offset:1024
  s_mov_b64 exec, -1
  s_waitcnt lgkmcnt(0)
  s_cmp_eq_u32 s55, 0
  s_cbranch_scc1 L_A_fs1
  s_barrier
  s_branch L_A_fs1d
L_A_fs1:
  v_mov_b32 v1, 10524
  v_mov_b32 v2, 1
  s_mov_b64 exec, 1
  ds_add_u32 v1, v2
  s_mov_b64 exec, -1
  s_mov_b32 s58, 0
  v_mov_b32 v1, 10524
L_spaop_3:
  ds_read_b32 v2, v1
  s_add_u32 s58, s58, 1
  s_waitcnt lgkmcnt(0)
  v_readfirstlane_b32 s57, v2
  s_cmp_gt_u32 s58, 200000
  s_cbranch_scc1 L_spdaop_4
  s_cmp_lt_u32 s57, 4
  s_cbranch_scc1 L_spaop_3
L_spdaop_4:
  s_mov_b32 s58, 0
  v_mov_b32 v1, 10512
L_spamode_5:
  ds_read_b32 v2, v1
  s_add_u32 s58, s58, 1
  s_waitcnt lgkmcnt(0)
  v_readfirstlane_b32 s57, v2
  s_cmp_gt_u32 s58, 200000
  s_cbranch_scc1 L_spdamode_6
  s_cmp_lt_u32 s57, 1
  s_cbranch_scc1 L_spamode_5
L_spdamode_6:
  s_mov_b32 s56, s57
L_A_fs1d:
  ds_read_b128 v[32:35], v15
  ds_read2_b32 v[36:37], v63 offset0:0 offset1:4
  ds_read2_b32 v[38:39], v63 offset0:8 offset1:12
  ds_read2st64_b32 v[40:41], v12 offset0:0 offset1:1
  ds_read2st64_b32 v[42:43], v12 offset0:8 offset1:9
  ds_read2st64_b32 v[44:45], v12 offset0:16 offset1:17
  ds_read2st64_b32 v[46:47], v12 offset0:24 offset1:25
  s_lshl_b32 s94, s55, 15
  s_lshl_b32 s95, s55, 10
  s_add_u32 s95, s95, s96
  v_mov_b32 v53, s95
  s_waitcnt lgkmcnt(6)
  v_max3_f32 v48, v32, v33, v34
  v_max_f32 v48, v48, v35
  v_sub_f32 v32, v32, v48
  v_sub_f32 v33, v33, v48
  v_sub_f32 v34, v34, v48
  v_sub_f32 v35, v35, v48
  v_exp_f32 v32, v32
  v_exp_f32 v33, v33
  v_exp_f32 v34, v34
  v_exp_f32 v35, v35
  s_waitcnt lgkmcnt(4)
  v_mul_f32 v49, v32, v36
  v_fmac_f32 v49, v33, v37
  v_fmac_f32 v49, v34, v38
  v_fmac_f32 v49, v35, v39
  v_rcp_f32 v50, v49
  s_waitcnt lgkmcnt(0)
  v_mul_f32 v51, v40, v32
  v_mul_f32 v52, v41, v32
  v_fmac_f32 v51, v42, v33
  v_fmac_f32 v52, v43, v33
  v_fmac_f32 v51, v44, v34
  v_fmac_f32 v52, v45, v34
  v_fmac_f32 v51, v46, v35
  v_fmac_f32 v52, v47, v35
  v_mul_f32 v51, v51, v50
  v_mul_f32 v52, v52, v50
  v_cvt_pk_bf16_f32 v51, v51, v52
  s_cmp_eq_u32 s56, 1
  s_cbranch_scc1 L_pf_7
  buffer_store_dword v51, v13, s[48:51], s94 offen sc1
  s_mov_b64 exec, 1
  buffer_store_dwordx2 v[48:49], v53, s[48:51], 0 offen sc1
  s_branch L_pd_8
L_pf_7:
  buffer_store_dword v51, v13, s[48:51], s94 offen
  s_mov_b64 exec, 1
  buffer_store_dwordx2 v[48:49], v53, s[48:51], 0 offen
L_pd_8:
  s_mov_b64 exec, -1
  s_cmp_lg_u32 s55, 0
  s_cbranch_scc1 L_A_done0
  v_mov_b32 v1, 10528
  v_mov_b32 v2, 1
  s_mov_b64 exec, 1
  ds_add_u32 v1, v2
  s_mov_b64 exec, -1
  s_mov_b32 s55, 1
  s_branch L_A_loop
L_A_done0:
  s_barrier
L_A_done:
  s_endpgm
L_H:
  s_mov_b32 s58, 0
  v_mov_b32 v1, 10532
L_sphinit_9:
  ds_read_b32 v2, v1
  s_add_u32 s58, s58, 1
  s_waitcnt lgkmcnt(0)
  v_readfirstlane_b32 s57, v2
  s_cmp_gt_u32 s58, 200000
  s_cbranch_scc1 L_spdhinit_10
  s_cmp_lt_u32 s57, 4
  s_cbranch_scc1 L_sphinit_9
L_spdhinit_10:
  s_getreg_b32 s91, hwreg(HW_REG_XCC_ID)
  s_and_b32 s91, s91, 15
  v_mov_b32 v20, s63
  v_mov_b32 v21, s91
  s_lshl_b32 s90, s53, 3
  s_add_u32 s90, s90, s52
  s_lshl_b32 s90, s90, 7
  s_add_u32 s90, s90, 2883584
  v_mov_b32 v9, s90
  s_waitcnt vmcnt(0)
  s_mov_b64 exec, 1
  s_setprio 3
  buffer_store_dwordx2 v[20:21], v9, s[48:51], 0 offen sc1
  s_setprio 0
  s_mov_b64 exec, -1
  v_mov_b32 v1, 10536
  v_mov_b32 v2, 1
  s_mov_b64 exec, 1
  ds_add_u32 v1, v2
  s_mov_b64 exec, -1
  v_lshlrev_b32 v9, 3, v0
  v_add_u32 v9, s52, v9
  v_subrev_u32 v10, 32, v0
  v_and_b32 v11, 3, v10
  s_lshl_b32 s90, s89, 2
  v_add_u32 v11, s90, v11
  v_lshlrev_b32 v11, 3, v11
  v_lshrrev_b32 v10, 2, v10
  v_add_u32 v11, v11, v10
  v_cmp_gt_u32 vcc, 32, v0
  s_nop 1
  v_cndmask_b32 v9, v11, v9, vcc
  v_lshlrev_b32 v9, 7, v9
  v_add_u32 v22, 65536, v9
  v_add_u32 v22, 2883584, v22
  v_add_u32 v9, 2883584, v9
  s_mov_b32 s58, 0
  s_sleep 60
L_hello_poll:
  s_sleep 16
  s_setprio 3
  buffer_load_dwordx2 v[12:13], v9, s[48:51], 0 offen sc1
  s_setprio 0
  s_add_u32 s58, s58, 1
  s_waitcnt vmcnt(0)
  v_cmp_ne_u32 vcc, s63, v12
  s_cbranch_vccz L_hello_done
  s_cmp_lt_u32 s58, 200000
  s_cbranch_scc1 L_hello_poll
L_hello_done:
  v_cmp_ne_u32 vcc, s91, v13
  s_nop 0
  s_cmp_eq_u32 vcc_lo, 0
  s_cselect_b32 s93, 1, 2
  s_cbranch_scc1 L_H_fast
  v_lshlrev_b32 v8, 4, v0
  v_mov_b32 v12, -1
  v_mov_b32 v13, -1
  v_mov_b32 v14, -1
  v_mov_b32 v15, -1
  s_mul_i32 s90, s53, 5120
  s_add_u32 s90, s90, s3
  buffer_store_dwordx4 v[12:15], v8, s[48:51], s90 offen sc1
  buffer_store_dwordx4 v[12:15], v8, s[48:51], s90 offen offset:1024 sc1
  buffer_store_dwordx4 v[12:15], v8, s[48:51], s90 offen offset:2048 sc1
  buffer_store_dwordx4 v[12:15], v8, s[48:51], s90 offen offset:3072 sc1
  s_add_u32 s90, s90, 4096
  buffer_store_dwordx4 v[12:15], v8, s[48:51], s90 offen sc1
  v_mov_b32 v20, s63
  s_lshl_b32 s90, s53, 3
  s_add_u32 s90, s90, s52
  s_lshl_b32 s90, s90, 7
  s_add_u32 s90, s90, 2949120
  v_mov_b32 v10, s90
  s_waitcnt vmcnt(0)
  s_mov_b64 exec, 1
  buffer_store_dword v20, v10, s[48:51], 0 offen sc1
  s_mov_b32 exec_lo, -1
  s_mov_b32 exec_hi, 0
  v_mov_b32 v9, v22
  s_mov_b32 s58, 0
L_H_poll2:
  buffer_load_dword v12, v9, s[48:51], 0 offen sc1
  s_add_u32 s58, s58, 1
  s_waitcnt vmcnt(0)
  v_cmp_ne_u32 vcc, s63, v12
  s_cbranch_vccz L_H_p2d
  s_sleep 8
  s_cmp_lt_u32 s58, 200000
  s_cbranch_scc1 L_H_poll2
L_H_p2d:
  s_mov_b64 exec, -1
L_H_fast:
  v_mov_b32 v12, s93
  v_mov_b32 v13, 10512
  s_mov_b64 exec, 1
  ds_write_b32 v13, v12
  s_mov_b64 exec, -1
  s_waitcnt lgkmcnt(0)
  v_mov_b32 v1, 10540
  v_mov_b32 v2, 1
  s_mov_b64 exec, 1
  ds_add_u32 v1, v2
  s_mov_b64 exec, -1
  s_mov_b32 s58, 0
  v_mov_b32 v1, 10548
L_sphvs_11:
  ds_read_b32 v2, v1
  s_add_u32 s58, s58, 1
  s_waitcnt lgkmcnt(0)
  v_readfirstlane_b32 s57, v2
  s_cmp_gt_u32 s58, 200000
  s_cbranch_scc1 L_spdhvs_12
  s_cmp_lt_u32 s57, 4
  s_cbranch_scc1 L_sphvs_11
L_spdhvs_12:
  v_lshlrev_b32 v8, 4, v0
  s_mul_i32 s90, s53, 5120
  s_add_u32 s90, s90, s3
  buffer_load_dwordx4 v[60:63], v8, s[48:51], s90 offen sc1
  buffer_load_dwordx4 v[64:67], v8, s[48:51], s90 offen offset:1024 sc1
  buffer_load_dwordx4 v[68:71], v8, s[48:51], s90 offen offset:2048 sc1
  buffer_load_dwordx4 v[72:75], v8, s[48:51], s90 offen offset:3072 sc1
  s_add_u32 s90, s90, 4096
  buffer_load_dwordx4 v[76:79], v8, s[48:51], s90 offen sc1
  s_endpgm
L_P:
  s_getpc_b64 s[8:9]
L_P_pc:
  s_sub_u32 s8, s8, L_P_pc-interleave_layers__sliding_block_cached__dense_activation_mish__decode_kernel
  s_subb_u32 s9, s9, 0
  s_mov_b32 s10, L_end+4-interleave_layers__sliding_block_cached__dense_activation_mish__decode_kernel
  s_mov_b32 s11, 0x20000
  v_lshlrev_b32 v8, 4, v0
  s_lshl_b32 s90, s53, 10
  s_setprio 3
  buffer_load_dwordx4 v[12:15], v8, s[8:11], s90 offen
  s_setprio 0
  s_mov_b32 s16, s72
  s_mov_b32 s17, s73
  s_mov_b32 s18, 4194304
  s_mov_b32 s19, 0x20000
  s_mov_b32 s4, s80
  s_mov_b32 s5, s81
  s_mov_b32 s6, 1835008
  s_mov_b32 s7, 0x20000
  v_lshrrev_b32 v10, 3, v0
  v_lshlrev_b32 v10, 10, v10
  v_and_b32 v11, 7, v0
  v_lshlrev_b32 v11, 4, v11
  v_add_u32 v10, v10, v11
  s_lshl_b32 s94, s52, 19
  s_lshl_b32 s95, s88, 17
  s_add_u32 s94, s94, s95
  s_lshl_b32 s95, s89, 7
  s_add_u32 s94, s94, s95
  s_mov_b32 s97, 28672
  s_mov_b32 m0, s97
  s_nop 0
  buffer_load_dwordx4 v10, s[16:19], s94 offen nt lds
  s_add_u32 s94, s94, 8192
  s_add_u32 s97, s97, 1024
  s_mov_b32 m0, s97
  s_nop 0
  buffer_load_dwordx4 v10, s[16:19], s94 offen nt lds
  s_add_u32 s94, s94, 8192
  s_add_u32 s97, s97, 1024
  s_mov_b32 m0, s97
  s_nop 0
  buffer_load_dwordx4 v10, s[16:19], s94 offen nt lds
  s_add_u32 s94, s94, 8192
  s_add_u32 s97, s97, 1024
  s_mov_b32 m0, s97
  s_nop 0
  buffer_load_dwordx4 v10, s[16:19], s94 offen nt lds
  s_add_u32 s94, s94, 8192
  s_add_u32 s97, s97, 1024
  s_mov_b32 m0, s97
  s_nop 0
  buffer_load_dwordx4 v10, s[16:19], s94 offen nt lds
  s_add_u32 s94, s94, 8192
  s_add_u32 s97, s97, 1024
  s_mov_b32 m0, s97
  s_nop 0
  buffer_load_dwordx4 v10, s[16:19], s94 offen nt lds
  s_add_u32 s94, s94, 8192
  s_add_u32 s97, s97, 1024
  s_mov_b32 m0, s97
  s_nop 0
  buffer_load_dwordx4 v10, s[16:19], s94 offen nt lds
  s_add_u32 s94, s94, 8192
  s_add_u32 s97, s97, 1024
  s_mov_b32 m0, s97
  s_nop 0
  buffer_load_dwordx4 v10, s[16:19], s94 offen nt lds
  s_add_u32 s94, s94, 8192
  s_add_u32 s97, s97, 1024
  s_mov_b32 m0, s97
  s_nop 0
  buffer_load_dwordx4 v10, s[16:19], s94 offen nt lds
  s_add_u32 s94, s94, 8192
  s_add_u32 s97, s97, 1024
  s_mov_b32 m0, s97
  s_nop 0
  buffer_load_dwordx4 v10, s[16:19], s94 offen nt lds
  s_add_u32 s94, s94, 8192
  s_add_u32 s97, s97, 1024
  s_mov_b32 m0, s97
  s_nop 0
  buffer_load_dwordx4 v10, s[16:19], s94 offen nt lds
  s_add_u32 s94, s94, 8192
  s_add_u32 s97, s97, 1024
  s_mov_b32 m0, s97
  s_nop 0
  buffer_load_dwordx4 v10, s[16:19], s94 offen nt lds
  s_add_u32 s94, s94, 8192
  s_add_u32 s97, s97, 1024
  s_mov_b32 m0, s97
  s_nop 0
  buffer_load_dwordx4 v10, s[16:19], s94 offen nt lds
  s_add_u32 s94, s94, 8192
  s_add_u32 s97, s97, 1024
  s_mov_b32 m0, s97
  s_nop 0
  buffer_load_dwordx4 v10, s[16:19], s94 offen nt lds
  s_add_u32 s94, s94, 8192
  s_add_u32 s97, s97, 1024
  s_mov_b32 m0, s97
  s_nop 0
  buffer_load_dwordx4 v10, s[16:19], s94 offen nt lds
  s_add_u32 s94, s94, 8192
  s_add_u32 s97, s97, 1024
  s_mov_b32 m0, s97
  s_nop 0
  buffer_load_dwordx4 v10, s[16:19], s94 offen nt lds
  s_add_u32 s94, s94, 8192
  s_add_u32 s97, s97, 1024
  s_waitcnt vmcnt(0)
  v_mov_b32 v1, 10500
  v_mov_b32 v2, 1
  s_mov_b64 exec, 1
  ds_add_u32 v1, v2
  s_mov_b64 exec, -1
  s_mov_b32 s8, s76
  s_mov_b32 s9, s77
  s_mov_b32 s10, 1835008
  s_mov_b32 s11, 0x20000
  v_lshrrev_b32 v11, 1, v0
  s_mov_b32 s92, 3584
  v_mul_lo_u32 v11, v11, s92
  v_and_b32 v12, 1, v0
  v_lshlrev_b32 v12, 4, v12
  v_add_u32 v11, v11, v12
  s_mul_i32 s92, s52, 448
  s_lshl_b32 s93, s53, 5
  s_add_u32 s92, s92, s93
  s_mov_b32 s96, 45056
  s_mov_b32 s58, 0
  v_mov_b32 v1, 10548
L_sppvi2_13:
  ds_read_b32 v2, v1
  s_add_u32 s58, s58, 1
  s_waitcnt lgkmcnt(0)
  v_readfirstlane_b32 s57, v2
  s_cmp_gt_u32 s58, 200000
  s_cbranch_scc1 L_spdpvi2_14
  s_cmp_lt_u32 s57, 4
  s_cbranch_scc1 L_sppvi2_13
L_spdpvi2_14:
  s_cmp_ge_u32 s53, 14
  s_cbranch_scc1 L_P_now1
  s_mov_b32 m0, s96
  s_nop 0
  buffer_load_dwordx4 v11, s[8:11], s92 offen  lds
  s_add_u32 s92, s92, 114688
  s_add_u32 s96, s96, 1024
  s_mov_b32 m0, s96
  s_nop 0
  buffer_load_dwordx4 v11, s[8:11], s92 offen  lds
  s_add_u32 s92, s92, 114688
  s_add_u32 s96, s96, 1024
  s_mov_b32 m0, s96
  s_nop 0
  buffer_load_dwordx4 v11, s[8:11], s92 offen  lds
  s_add_u32 s92, s92, 114688
  s_add_u32 s96, s96, 1024
  s_mov_b32 m0, s96
  s_nop 0
  buffer_load_dwordx4 v11, s[8:11], s92 offen  lds
  s_add_u32 s92, s92, 114688
  s_add_u32 s96, s96, 1024
  s_mov_b32 m0, s96
  s_nop 0
  buffer_load_dwordx4 v11, s[8:11], s92 offen  lds
  s_add_u32 s92, s92, 114688
  s_add_u32 s96, s96, 1024
  s_mov_b32 m0, s96
  s_nop 0
  buffer_load_dwordx4 v11, s[8:11], s92 offen  lds
  s_add_u32 s92, s92, 114688
  s_add_u32 s96, s96, 1024
  s_mov_b32 m0, s96
  s_nop 0
  buffer_load_dwordx4 v11, s[8:11], s92 offen  lds
  s_add_u32 s92, s92, 114688
  s_add_u32 s96, s96, 1024
  s_mov_b32 m0, s96
  s_nop 0
  buffer_load_dwordx4 v11, s[8:11], s92 offen  lds
  s_add_u32 s92, s92, 114688
  s_add_u32 s96, s96, 1024
  s_mov_b32 m0, s96
  s_nop 0
  buffer_load_dwordx4 v11, s[8:11], s92 offen  lds
  s_add_u32 s92, s92, 114688
  s_add_u32 s96, s96, 1024
  s_mov_b32 m0, s96
  s_nop 0
  buffer_load_dwordx4 v11, s[8:11], s92 offen  lds
  s_add_u32 s92, s92, 114688
  s_add_u32 s96, s96, 1024
  s_mov_b32 m0, s96
  s_nop 0
  buffer_load_dwordx4 v11, s[8:11], s92 offen  lds
  s_add_u32 s92, s92, 114688
  s_add_u32 s96, s96, 1024
  s_mov_b32 m0, s96
  s_nop 0
  buffer_load_dwordx4 v11, s[8:11], s92 offen  lds
  s_add_u32 s92, s92, 114688
  s_add_u32 s96, s96, 1024
  s_mov_b32 m0, s96
  s_nop 0
  buffer_load_dwordx4 v11, s[8:11], s92 offen  lds
  s_add_u32 s92, s92, 114688
  s_add_u32 s96, s96, 1024
  s_mov_b32 m0, s96
  s_nop 0
  buffer_load_dwordx4 v11, s[8:11], s92 offen  lds
  s_add_u32 s92, s92, 114688
  s_add_u32 s96, s96, 1024
  s_mov_b32 m0, s96
  s_nop 0
  buffer_load_dwordx4 v11, s[8:11], s92 offen  lds
  s_add_u32 s92, s92, 114688
  s_add_u32 s96, s96, 1024
  s_mov_b32 m0, s96
  s_nop 0
  buffer_load_dwordx4 v11, s[8:11], s92 offen  lds
  s_add_u32 s92, s92, 114688
  s_add_u32 s96, s96, 1024
L_P_now1:
  s_mul_i32 s94, s52, 229376
  s_and_b32 s95, s53, 1
  s_mul_i32 s95, s95, 114688
  s_add_u32 s94, s94, s95
  s_lshr_b32 s95, s53, 1
  s_lshl_b32 s95, s95, 6
  s_add_u32 s94, s94, s95
  v_lshrrev_b32 v10, 2, v0
  v_lshlrev_b32 v10, 10, v10
  v_and_b32 v12, 3, v0
  v_lshlrev_b32 v12, 4, v12
  v_add_u32 v10, v10, v12
  s_mov_b32 s97, 61440
  s_mov_b32 m0, s97
  s_nop 0
  buffer_load_dwordx4 v10, s[4:7], s94 offen  lds
  s_add_u32 s94, s94, 16384
  s_add_u32 s97, s97, 1024
  s_mov_b32 m0, s97
  s_nop 0
  buffer_load_dwordx4 v10, s[4:7], s94 offen  lds
  s_add_u32 s94, s94, 16384
  s_add_u32 s97, s97, 1024
  s_mov_b32 m0, s97
  s_nop 0
  buffer_load_dwordx4 v10, s[4:7], s94 offen  lds
  s_add_u32 s94, s94, 16384
  s_add_u32 s97, s97, 1024
  s_mov_b32 m0, s97
  s_nop 0
  buffer_load_dwordx4 v10, s[4:7], s94 offen  lds
  s_add_u32 s94, s94, 16384
  s_add_u32 s97, s97, 1024
  s_mov_b32 m0, s97
  s_nop 0
  buffer_load_dwordx4 v10, s[4:7], s94 offen  lds
  s_add_u32 s94, s94, 16384
  s_add_u32 s97, s97, 1024
  s_mov_b32 m0, s97
  s_nop 0
  buffer_load_dwordx4 v10, s[4:7], s94 offen  lds
  s_add_u32 s94, s94, 16384
  s_add_u32 s97, s97, 1024
  s_mov_b32 m0, s97
  s_nop 0
  buffer_load_dwordx4 v10, s[4:7], s94 offen  lds
  s_add_u32 s94, s94, 16384
  s_add_u32 s97, s97, 1024
  s_mov_b32 s94, 0x8000000
  s_mov_b32 m0, s97
  s_nop 0
  buffer_load_dwordx4 v10, s[4:7], s94 offen  lds
  s_add_u32 s94, s94, 16384
  s_add_u32 s97, s97, 1024
  s_waitcnt vmcnt(0)
  v_mov_b32 v1, 10504
  v_mov_b32 v2, 1
  s_mov_b64 exec, 1
  ds_add_u32 v1, v2
  s_mov_b64 exec, -1
  s_endpgm
L_C:
  s_mov_b32 s12, s78
  s_mov_b32 s13, s79
  s_mov_b32 s14, 3584
  s_mov_b32 s15, 0x20000
  s_mov_b32 s16, s82
  s_mov_b32 s17, s83
  s_mov_b32 s18, 8192
  s_mov_b32 s19, 0x20000
  v_lshlrev_b32 v240, 4, v0
  v_mov_b32 v241, v240
  v_lshrrev_b32 v8, 1, v6
  s_lshl_b32 s90, s60, 2
  v_add_u32 v8, s90, v8
  v_and_b32 v9, 1, v4
  v_lshlrev_b32 v255, 10, v8
  v_lshlrev_b32 v10, 4, v9
  v_add_u32 v255, v255, v10
  v_lshlrev_b32 v10, 3, v5
  v_add_u32 v255, v255, v10
  s_lshl_b32 s90, s53, 5
  v_add_u32 v255, s90, v255
  v_lshlrev_b32 v10, 4, v9
  v_add_u32 v10, v10, v8
  s_and_b32 s90, s53, 1
  s_lshl_b32 s90, s90, 5
  s_lshr_b32 s91, s53, 1
  s_and_b32 s91, s91, 1
  s_lshl_b32 s91, s91, 3
  s_add_u32 s90, s90, s91
  v_add_u32 v10, s90, v10
  v_lshlrev_b32 v245, 4, v10
  v_lshlrev_b32 v10, 3, v5
  v_add_u32 v245, v245, v10
  s_lshr_b32 s90, s53, 2
  s_lshl_b32 s90, s90, 10
  v_add_u32 v245, s90, v245
  s_lshr_b32 s90, s53, 3
  s_lshl_b32 s90, s90, 4
  s_lshr_b32 s91, s53, 2
  s_and_b32 s91, s91, 1
  s_lshl_b32 s91, s91, 3
  s_add_u32 s90, s90, s91
  v_add_u32 v10, s90, v8
  v_lshlrev_b32 v246, 4, v10
  s_and_b32 s90, s53, 2
  s_lshl_b32 s90, s90, 9
  s_and_b32 s91, s53, 1
  s_lshl_b32 s91, s91, 3
  s_add_u32 s90, s90, s91
  v_add_u32 v246, s90, v246
  s_mul_i32 s90, s52, 448
  s_lshl_b32 s91, s53, 5
  s_add_u32 s90, s90, s91
  v_lshlrev_b32 v9, 3, v5
  v_lshlrev_b32 v10, 2, v7
  v_add_u32 v9, v9, v10
  s_setprio 3
  buffer_load_dword v238, v9, s[12:15], s90 offen
  s_setprio 0
  v_lshlrev_b32 v242, 10, v6
  v_lshlrev_b32 v9, 5, v7
  v_add_u32 v242, v242, v9
  v_lshlrev_b32 v9, 3, v5
  v_add_u32 v242, v242, v9
  s_lshl_b32 s90, s88, 13
  s_lshl_b32 s91, s89, 7
  s_add_u32 s90, s90, s91
  s_lshl_b32 s91, s60, 6
  s_add_u32 s90, s90, s91
  v_add_u32 v242, s90, v242
  v_lshlrev_b32 v243, 13, v5
  v_lshlrev_b32 v9, 4, v4
  v_add_u32 v243, v243, v9
  s_lshl_b32 s90, s89, 10
  s_lshl_b32 s91, s60, 9
  s_add_u32 s90, s90, s91
  v_add_u32 v243, s90, v243
  v_lshlrev_b32 v250, 4, v4
  v_lshlrev_b32 v9, 3, v5
  v_add_u32 v250, v250, v9
  s_lshl_b32 s90, s60, 9
  s_add_u32 s90, s90, 9216
  v_add_u32 v250, s90, v250
  v_lshlrev_b32 v244, 1, v5
  v_add_u32 v244, v244, v7
  v_lshlrev_b32 v244, 8, v244
  v_lshlrev_b32 v9, 4, v6
  v_add_u32 v244, v244, v9
  s_lshl_b32 s90, s53, 13
  s_lshl_b32 s91, s60, 7
  s_add_u32 s90, s90, s91
  v_add_u32 v244, s90, v244
  v_lshlrev_b32 v9, 2, v5
  v_lshlrev_b32 v10, 1, v7
  v_add_u32 v9, v9, v10
  s_lshl_b32 s90, s53, 4
  v_add_u32 v9, s90, v9
  v_mov_b32 v10, 0
  v_cmp_le_u32 vcc, 112, v9
  s_nop 1
  v_addc_co_u32 v10, vcc, 0, v10, vcc
  v_mul_u32_u24 v11, 112, v10
  v_sub_u32 v9, v9, v11
  v_lshlrev_b32 v247, 11, v10
  v_lshrrev_b32 v11, 6, v9
  v_lshlrev_b32 v11, 10, v11
  v_add_u32 v247, v247, v11
  v_bfe_u32 v11, v9, 3, 2
  v_lshlrev_b32 v11, 8, v11
  v_add_u32 v247, v247, v11
  v_bfe_u32 v11, v9, 5, 1
  v_lshlrev_b32 v11, 7, v11
  v_add_u32 v247, v247, v11
  v_lshlrev_b32 v11, 4, v6
  v_add_u32 v247, v247, v11
  v_and_b32 v11, 7, v9
  v_lshlrev_b32 v11, 1, v11
  v_add_u32 v247, v247, v11
  s_add_u32 s90, s3, 135168
  v_add_u32 v247, s90, v247
  v_lshlrev_b32 v248, 4, v0
  s_and_b32 s91, s53, 1
  s_lshl_b32 s91, s91, 11
  s_add_u32 s90, s90, s91
  v_add_u32 v248, s90, v248
  v_lshlrev_b32 v249, 13, v7
  v_lshlrev_b32 v9, 5, v6
  v_add_u32 v249, v249, v9
  v_lshlrev_b32 v9, 3, v5
  v_add_u32 v249, v249, v9
  s_lshl_b32 s90, s89, 15
  s_lshl_b32 s91, s60, 14
  s_add_u32 s90, s90, s91
  s_lshl_b32 s91, s52, 2
  s_add_u32 s91, s91, s88
  s_lshl_b32 s91, s91, 8
  s_add_u32 s90, s90, s91
  v_add_u32 v249, s90, v249
  v_lshlrev_b32 v252, 4, v0
  s_lshl_b32 s91, s88, 13
  s_add_u32 s90, s3, s91
  s_add_u32 s90, s90, 65536
  v_add_u32 v252, s90, v252
  s_lshl_b32 s91, s88, 8
  s_add_u32 s90, s3, s91
  s_add_u32 s90, s90, 131072
  v_lshlrev_b32 v253, 4, v6
  v_add_u32 v253, s90, v253
  v_and_b32 v9, 2, v0
  v_lshlrev_b32 v254, 9, v9
  v_bfe_u32 v9, v0, 3, 2
  v_lshlrev_b32 v9, 8, v9
  v_add_u32 v254, v254, v9
  v_bfe_u32 v9, v0, 2, 1
  v_lshlrev_b32 v9, 7, v9
  v_add_u32 v254, v254, v9
  v_and_b32 v9, 1, v0
  v_lshlrev_b32 v9, 3, v9
  v_add_u32 v254, v254, v9
  s_lshl_b32 s90, s89, 4
  s_add_u32 s90, s90, s3
  s_add_u32 s90, s90, 26624
  v_add_u32 v254, s90, v254
  v_lshlrev_b32 v12, 3, v5
  v_lshrrev_b32 v13, 2, v4
  v_add_u32 v12, v12, v13
  v_and_b32 v13, 3, v4
  v_lshlrev_b32 v13, 3, v13
  v_lshlrev_b32 v251, 7, v12
  v_add_u32 v251, v251, v13
  s_lshl_b32 s90, s60, 6
  v_add_u32 v251, s90, v251
  v_mov_b32 v224, 0
  v_mov_b32 v225, 0
  v_mov_b32 v226, 0
  v_mov_b32 v227, 0
  v_and_b32 v9, 1, v4
  v_lshlrev_b32 v9, 4, v9
  v_mov_b32 v10, 0x3f80
  v_lshlrev_b32 v10, v9, v10
  v_lshrrev_b32 v11, 1, v4
  v_cmp_eq_u32 vcc, 0, v11
  s_nop 1
  v_cndmask_b32 v224, v224, v10, vcc
  v_cmp_eq_u32 vcc, 1, v11
  s_nop 1
  v_cndmask_b32 v225, v225, v10, vcc
  v_cmp_eq_u32 vcc, 2, v11
  s_nop 1
  v_cndmask_b32 v226, v226, v10, vcc
  v_cmp_eq_u32 vcc, 3, v11
  s_nop 1
  v_cndmask_b32 v227, v227, v10, vcc
  s_mov_b32 s58, 0
  v_mov_b32 v1, 10496
L_spwq_15:
  ds_read_b32 v2, v1
  s_add_u32 s58, s58, 1
  s_waitcnt lgkmcnt(0)
  v_readfirstlane_b32 s57, v2
  s_cmp_gt_u32 s58, 200000
  s_cbranch_scc1 L_spdwq_16
  s_cmp_lt_u32 s57, 4
  s_cbranch_scc1 L_spwq_15
L_spdwq_16:
  s_mov_b32 s58, 0
  v_mov_b32 v1, 10532
L_spcinit_17:
  ds_read_b32 v2, v1
  s_add_u32 s58, s58, 1
  s_waitcnt lgkmcnt(0)
  v_readfirstlane_b32 s57, v2
  s_cmp_gt_u32 s58, 200000
  s_cbranch_scc1 L_spdcinit_18
  s_cmp_lt_u32 s57, 4
  s_cbranch_scc1 L_spcinit_17
L_spdcinit_18:
  v_and_b32 v14, 7, v0
  v_lshlrev_b32 v14, 10, v14
  v_bfe_u32 v15, v0, 3, 1
  v_lshlrev_b32 v15, 6, v15
  v_add_u32 v14, v14, v15
  v_lshrrev_b32 v15, 4, v0
  v_lshlrev_b32 v15, 4, v15
  v_add_u32 v14, v14, v15
  v_add_u32 v14, 69632, v14
  s_lshl_b32 s90, s88, 8
  v_add_u32 v15, s90, v14
  ds_read_b128 v[56:59], v15
  ds_read_b128 v[60:63], v15 offset:128
  v_add_u32 v15, 12288, v251
  ds_read_b64_tr_b16 v[64:65], v15 offset:0
  ds_read_b64_tr_b16 v[66:67], v15 offset:512
  ds_read_b64_tr_b16 v[68:69], v15 offset:4096
  ds_read_b64_tr_b16 v[70:71], v15 offset:4608
  ds_read_b64_tr_b16 v[72:73], v15 offset:8192
  ds_read_b64_tr_b16 v[74:75], v15 offset:8704
  ds_read_b64_tr_b16 v[76:77], v15 offset:12288
  ds_read_b64_tr_b16 v[78:79], v15 offset:12800
  ds_read_b64_tr_b16 v[80:81], v15 offset:32
  ds_read_b64_tr_b16 v[82:83], v15 offset:544
  ds_read_b64_tr_b16 v[84:85], v15 offset:4128
  ds_read_b64_tr_b16 v[86:87], v15 offset:4640
  ds_read_b64_tr_b16 v[88:89], v15 offset:8224
  ds_read_b64_tr_b16 v[90:91], v15 offset:8736
  ds_read_b64_tr_b16 v[92:93], v15 offset:12320
  ds_read_b64_tr_b16 v[94:95], v15 offset:12832
  v_add_u32 v15, 69632, v255
  ds_read_b64 v[54:55], v15
  s_lshl_b32 s90, s89, 10
  s_add_u32 s90, s90, 69632
  v_lshlrev_b32 v15, 4, v0
  v_add_u32 v15, s90, v15
  ds_read_b128 v[48:51], v15
  v_mov_b32 v8, 0x3f803f80
  v_mov_b32 v9, 0x3f803f80
  v_mov_b32 v10, 0x3f803f80
  v_mov_b32 v11, 0x3f803f80
  s_mul_i32 s97, s52, 0x14000
  s_add_u32 s97, s97, 3211264
  v_and_b32 v12, 0x3ff, v242
  v_lshlrev_b32 v12, 1, v12
  s_mul_i32 s90, s88, 0x5000
  v_add_u32 v12, s90, v12
  v_lshrrev_b32 v13, 10, v242
  v_and_b32 v13, 7, v13
  v_lshlrev_b32 v13, 11, v13
  v_add_u32 v13, v13, v12
  v_add_u32 v12, 16384, v12
  s_waitcnt lgkmcnt(2)
  v_mfma_f32_16x16x32_bf16 v[16:19], v[64:67], v[56:59], 0
  v_mfma_f32_16x16x32_bf16 v[20:23], v[68:71], v[56:59], 0
  v_mfma_f32_16x16x32_bf16 v[24:27], v[80:83], v[56:59], 0
  v_mfma_f32_16x16x32_bf16 v[28:31], v[84:87], v[56:59], 0
  v_mfma_f32_16x16x32_bf16 v[16:19], v[72:75], v[60:63], v[16:19]
  v_mfma_f32_16x16x32_bf16 v[20:23], v[76:79], v[60:63], v[20:23]
  v_mfma_f32_16x16x32_bf16 v[24:27], v[88:91], v[60:63], v[24:27]
  v_mfma_f32_16x16x32_bf16 v[28:31], v[92:95], v[60:63], v[28:31]
  v_mfma_f32_16x16x32_bf16 v[32:35], v[64:67], v[8:11], 0
  v_mfma_f32_16x16x32_bf16 v[36:39], v[68:71], v[8:11], 0
  v_mfma_f32_16x16x32_bf16 v[40:43], v[80:83], v[8:11], 0
  v_mfma_f32_16x16x32_bf16 v[44:47], v[84:87], v[8:11], 0
  v_mfma_f32_16x16x32_bf16 v[32:35], v[72:75], v[8:11], v[32:35]
  v_mfma_f32_16x16x32_bf16 v[36:39], v[76:79], v[8:11], v[36:39]
  v_mfma_f32_16x16x32_bf16 v[40:43], v[88:91], v[8:11], v[40:43]
  v_mfma_f32_16x16x32_bf16 v[44:47], v[92:95], v[8:11], v[44:47]
  v_add_f32_dpp v4, v20, v16 row_ror:8 row_mask:0xf bank_mask:0x3
  v_add_f32_dpp v5, v21, v17 row_ror:8 row_mask:0xf bank_mask:0x3
  v_add_f32_dpp v6, v22, v18 row_ror:8 row_mask:0xf bank_mask:0x3
  v_add_f32_dpp v7, v23, v19 row_ror:8 row_mask:0xf bank_mask:0x3
  v_add_f32_dpp v4, v24, v28 row_ror:8 row_mask:0xf bank_mask:0xc
  v_add_f32_dpp v5, v25, v29 row_ror:8 row_mask:0xf bank_mask:0xc
  v_add_f32_dpp v6, v26, v30 row_ror:8 row_mask:0xf bank_mask:0xc
  v_add_f32_dpp v7, v27, v31 row_ror:8 row_mask:0xf bank_mask:0xc
  v_cvt_pk_bf16_f32 v4, v4, v5
  v_cvt_pk_bf16_f32 v6, v6, v7
  v_mov_b32 v5, s63
  v_mov_b32 v7, s63
  s_setprio 3
  buffer_store_dwordx4 v[4:7], v13, s[48:51], s97 offen
  s_setprio 0
  v_add_f32_dpp v8, v36, v32 row_ror:8 row_mask:0xf bank_mask:0x3
  v_add_f32_dpp v9, v37, v33 row_ror:8 row_mask:0xf bank_mask:0x3
  v_add_f32_dpp v10, v38, v34 row_ror:8 row_mask:0xf bank_mask:0x3
  v_add_f32_dpp v11, v39, v35 row_ror:8 row_mask:0xf bank_mask:0x3
  v_add_f32_dpp v8, v40, v44 row_ror:8 row_mask:0xf bank_mask:0xc
  v_add_f32_dpp v9, v41, v45 row_ror:8 row_mask:0xf bank_mask:0xc
  v_add_f32_dpp v10, v42, v46 row_ror:8 row_mask:0xf bank_mask:0xc
  v_add_f32_dpp v11, v43, v47 row_ror:8 row_mask:0xf bank_mask:0xc
  v_cvt_pk_bf16_f32 v8, v8, v9
  v_cvt_pk_bf16_f32 v10, v10, v11
  v_mov_b32 v9, s63
  v_mov_b32 v11, s63
  s_mov_b32 exec_lo, 0x01010101
  s_mov_b32 exec_hi, 0x01010101
  s_setprio 3
  buffer_store_dwordx4 v[8:11], v12, s[48:51], s97 offen
  s_setprio 0
  s_mov_b64 exec, -1
  s_mov_b32 s96, 0
  v_mov_b32 v3, v12
  s_waitcnt lgkmcnt(0) vmcnt(2)
  v_lshlrev_b32 v228, 16, v54
  v_and_b32 v229, 0xffff0000, v54
  v_lshlrev_b32 v230, 16, v55
  v_and_b32 v231, 0xffff0000, v55
  v_and_b32 v239, 0xffff0000, v238
  v_lshlrev_b32 v238, 16, v238
  v_mov_b32 v1, 0x3f803f80
  v_mov_b32 v52, 0
  v_mov_b32 v53, 0
  v_dot2_f32_bf16 v52, v48, v1, v52
  v_dot2_f32_bf16 v53, v48, v48, v53
  v_dot2_f32_bf16 v52, v49, v1, v52
  v_dot2_f32_bf16 v53, v49, v49, v53
  v_dot2_f32_bf16 v52, v50, v1, v52
  v_dot2_f32_bf16 v53, v50, v50, v53
  v_dot2_f32_bf16 v52, v51, v1, v52
  v_dot2_f32_bf16 v53, v51, v51, v53
  s_nop 1
  v_add_f32_dpp v52, v52, v52 row_ror:1 row_mask:0xf bank_mask:0xf
  v_add_f32_dpp v53, v53, v53 row_ror:1 row_mask:0xf bank_mask:0xf
  s_nop 0
  v_add_f32_dpp v52, v52, v52 row_ror:2 row_mask:0xf bank_mask:0xf
  v_add_f32_dpp v53, v53, v53 row_ror:2 row_mask:0xf bank_mask:0xf
  s_nop 0
  v_add_f32_dpp v52, v52, v52 row_ror:4 row_mask:0xf bank_mask:0xf
  v_add_f32_dpp v53, v53, v53 row_ror:4 row_mask:0xf bank_mask:0xf
  s_nop 0
  v_add_f32_dpp v52, v52, v52 row_ror:8 row_mask:0xf bank_mask:0xf
  v_add_f32_dpp v53, v53, v53 row_ror:8 row_mask:0xf bank_mask:0xf
  v_mov_b32 v54, v52
  v_mov_b32 v55, v53
  s_nop 0
  v_permlane16_swap_b32 v52, v54
  v_permlane16_swap_b32 v53, v55
  v_add_f32 v52, v52, v54
  v_add_f32 v53, v53, v55
  v_mov_b32 v54, v52
  v_mov_b32 v55, v53
  s_nop 0
  v_permlane32_swap_b32 v52, v54
  v_permlane32_swap_b32 v53, v55
  v_add_f32 v52, v52, v54
  v_add_f32 v53, v53, v55
  v_mul_f32 v52, 0x3b000000, v52
  v_mul_f32 v54, 0x3b000000, v53
  v_fma_f32 v54, -v52, v52, v54
  v_max_f32 v54, 0, v54
  v_add_f32 v54, 0x3727c5ac, v54
  v_rsq_f32 v15, v54
  s_nop 0
  v_mul_f32 v15, 0x3e0293ee, v15
  v_mul_f32 v14, -v52, v15
  v_lshrrev_b32 v16, 4, v0
  v_mul_u32_u24 v12, 0x5000, v16
  v_and_b32 v2, 15, v0
  v_lshlrev_b32 v2, 5, v2
  v_add_u32 v12, v12, v2
  s_lshl_b32 s90, s60, 10
  v_add_u32 v12, s90, v12
  s_lshl_b32 s93, s89, 11
  s_add_u32 s93, s93, s97
  s_add_u32 s92, s97, 16384
  s_mov_b32 s58, 0
  s_mov_b32 s99, 0
  s_sleep 14
L_C_g0poll:
  s_sleep 0
  v_mov_b32 v1, 10512
  ds_read_b32 v2, v1
  s_waitcnt lgkmcnt(0)
  v_readfirstlane_b32 s57, v2
  s_nop 0
  s_cmp_lg_u32 s57, 2
  s_cbranch_scc1 L_C_g0nr
  s_cmp_lg_u32 s96, 0
  s_cbranch_scc1 L_C_g0nr
  buffer_store_dwordx4 v[4:7], v13, s[48:51], s97 offen sc1
  s_mov_b32 exec_lo, 0x01010101
  s_mov_b32 exec_hi, 0x01010101
  buffer_store_dwordx4 v[8:11], v3, s[48:51], s97 offen sc1
  s_mov_b64 exec, -1
  s_mov_b32 s96, 1
L_C_g0nr:
  s_setprio 3
  buffer_load_dwordx4 v[16:19], v12, s[48:51], s93 offen offset:0 sc1
  buffer_load_dwordx4 v[20:23], v12, s[48:51], s93 offen offset:16 sc1
  buffer_load_dwordx4 v[24:27], v12, s[48:51], s93 offen offset:512 sc1
  buffer_load_dwordx4 v[28:31], v12, s[48:51], s93 offen offset:528 sc1
  buffer_load_dwordx4 v[32:35], v12, s[48:51], s92 offen offset:0 sc1
  buffer_load_dwordx4 v[36:39], v12, s[48:51], s92 offen offset:16 sc1
  buffer_load_dwordx4 v[40:43], v12, s[48:51], s92 offen offset:512 sc1
  buffer_load_dwordx4 v[44:47], v12, s[48:51], s92 offen offset:528 sc1
  s_setprio 0
  s_cmp_lg_u32 s99, 0
  s_cbranch_scc1 L_C_g0gi
  s_mov_b32 s99, 1
  v_mov_b32 v1, 10544
  v_mov_b32 v2, 1
  s_mov_b64 exec, 1
  ds_add_u32 v1, v2
  s_mov_b64 exec, -1
L_C_g0gi:
  s_waitcnt vmcnt(0)
  s_mov_b64 s[94:95], 0
  v_cmp_ne_u32 vcc, s63, v17
  s_nop 0
  s_or_b64 s[94:95], s[94:95], vcc
  v_cmp_ne_u32 vcc, s63, v21
  s_nop 0
  s_or_b64 s[94:95], s[94:95], vcc
  v_cmp_ne_u32 vcc, s63, v25
  s_nop 0
  s_or_b64 s[94:95], s[94:95], vcc
  v_cmp_ne_u32 vcc, s63, v29
  s_nop 0
  s_or_b64 s[94:95], s[94:95], vcc
  v_cmp_ne_u32 vcc, s63, v33
  s_nop 0
  s_or_b64 s[94:95], s[94:95], vcc
  v_cmp_ne_u32 vcc, s63, v37
  s_nop 0
  s_or_b64 s[94:95], s[94:95], vcc
  v_cmp_ne_u32 vcc, s63, v41
  s_nop 0
  s_or_b64 s[94:95], s[94:95], vcc
  v_cmp_ne_u32 vcc, s63, v45
  s_nop 0
  s_or_b64 s[94:95], s[94:95], vcc
  s_mov_b64 vcc, s[94:95]
  s_cbranch_vccz L_ok_19
  s_add_u32 s58, s58, 1
  s_cmp_lt_u32 s58, 200000
  s_cbranch_scc1 L_C_g0poll
L_ok_19:
  v_mov_b32 v48, v16
  v_mov_b32 v49, v18
  v_mov_b32 v50, v20
  v_mov_b32 v51, v22
  v_mov_b32 v52, v24
  v_mov_b32 v53, v26
  v_mov_b32 v54, v28
  v_mov_b32 v55, v30
  v_mov_b32 v56, v32
  v_mov_b32 v57, v34
  v_mov_b32 v58, v36
  v_mov_b32 v59, v38
  v_mov_b32 v60, v40
  v_mov_b32 v61, v42
  v_mov_b32 v62, v44
  v_mov_b32 v63, v46
  v_mfma_f32_16x16x32_bf16 v[32:35], v[224:227], v[48:51], 0
  v_mfma_f32_16x16x32_bf16 v[36:39], v[224:227], v[52:55], 0
  v_mfma_f32_16x16x32_bf16 v[24:27], v[224:227], v[56:59], 0
  v_mfma_f32_16x16x32_bf16 v[28:31], v[224:227], v[60:63], 0
  s_nop 6
  v_mul_f32 v40, v24, v14
  v_mul_f32 v41, v25, v14
  v_mul_f32 v42, v26, v14
  v_mul_f32 v43, v27, v14
  v_mul_f32 v44, v28, v14
  v_mul_f32 v45, v29, v14
  v_mul_f32 v46, v30, v14
  v_mul_f32 v47, v31, v14
  v_cvt_pk_bf16_f32 v232, v24, v25
  v_cvt_pk_bf16_f32 v233, v26, v27
  v_cvt_pk_bf16_f32 v234, v28, v29
  v_cvt_pk_bf16_f32 v235, v30, v31
  s_branch L_C_gdone
L_C_loop:
  s_lshl_b32 s92, s88, 11
  s_add_u32 s90, s3, s92
  s_add_u32 s90, s90, 8192
  s_mov_b32 s58, 0
  s_sleep 3
  buffer_load_dwordx4 v[56:59], v240, s[48:51], s90 offen
  buffer_load_dwordx4 v[60:63], v240, s[48:51], s90 offen offset:1024
  buffer_load_dwordx2 v[52:53], v254, s[48:51], 0 offen sc1
  s_branch L_C_qgo
L_C_qpoll:
  buffer_load_dwordx4 v[56:59], v240, s[48:51], s90 offen sc1
  buffer_load_dwordx4 v[60:63], v240, s[48:51], s90 offen offset:1024 sc1
  buffer_load_dwordx2 v[52:53], v254, s[48:51], 0 offen sc1
L_C_qgo:
  s_waitcnt vmcnt(2)
  v_mfma_f32_16x16x32_bf16 v[16:19], v[64:67], v[56:59], 0
  v_mfma_f32_16x16x32_bf16 v[20:23], v[68:71], v[56:59], 0
  v_mfma_f32_16x16x32_bf16 v[24:27], v[80:83], v[56:59], 0
  v_mfma_f32_16x16x32_bf16 v[28:31], v[84:87], v[56:59], 0
  s_waitcnt vmcnt(1)
  v_mfma_f32_16x16x32_bf16 v[16:19], v[72:75], v[60:63], v[16:19]
  v_max_u32 v1, v56, v60
  v_mfma_f32_16x16x32_bf16 v[20:23], v[76:79], v[60:63], v[20:23]
  v_cmp_eq_u32 vcc, -1, v1
  v_mfma_f32_16x16x32_bf16 v[24:27], v[88:91], v[60:63], v[24:27]
  v_mfma_f32_16x16x32_bf16 v[28:31], v[92:95], v[60:63], v[28:31]
  s_cbranch_vccz L_ok_20
  s_add_u32 s58, s58, 1
  s_cmp_lt_u32 s58, 200000
  s_cbranch_scc1 L_C_qpoll
L_ok_20:
  s_nop 3
  v_add_f32_dpp v8, v20, v16 row_ror:8 row_mask:0xf bank_mask:0x3
  v_add_f32_dpp v9, v21, v17 row_ror:8 row_mask:0xf bank_mask:0x3
  v_add_f32_dpp v10, v22, v18 row_ror:8 row_mask:0xf bank_mask:0x3
  v_add_f32_dpp v11, v23, v19 row_ror:8 row_mask:0xf bank_mask:0x3
  v_add_f32_dpp v8, v24, v28 row_ror:8 row_mask:0xf bank_mask:0xc
  v_add_f32_dpp v9, v25, v29 row_ror:8 row_mask:0xf bank_mask:0xc
  v_add_f32_dpp v10, v26, v30 row_ror:8 row_mask:0xf bank_mask:0xc
  v_add_f32_dpp v11, v27, v31 row_ror:8 row_mask:0xf bank_mask:0xc
  v_cvt_pk_bf16_f32 v8, v8, v9
  v_cvt_pk_bf16_f32 v9, v10, v11
  s_add_u32 s94, s3, 32768
  v_mov_b32 v10, v8
  v_mov_b32 v11, v9
  s_nop 0
  v_permlane16_swap_b32 v8, v10
  v_permlane16_swap_b32 v9, v11
  s_mov_b32 exec_lo, 0x0000ffff
  s_mov_b32 exec_hi, 0x0000ffff
  s_cmp_eq_u32 s56, 1
  s_cbranch_scc1 L_pf_21
  buffer_store_dwordx4 v[8:11], v242, s[48:51], s94 offen sc1
  s_branch L_pd_22
L_pf_21:
  buffer_store_dwordx4 v[8:11], v242, s[48:51], s94 offen
L_pd_22:
  s_mov_b64 exec, -1
  s_mov_b32 s58, 0
  s_waitcnt vmcnt(1)
  v_cmp_eq_u32 vcc, -1, v52
  s_cbranch_vccz L_C_sok
L_C_spoll:
  buffer_load_dwordx2 v[52:53], v254, s[48:51], 0 offen sc1
  s_waitcnt vmcnt(0)
  v_cmp_eq_u32 vcc, -1, v52
  s_cbranch_vccz L_ok_23
  s_add_u32 s58, s58, 1
  s_cmp_lt_u32 s58, 200000
  s_cbranch_scc1 L_C_spoll
L_ok_23:
L_C_sok:
  v_add_f32_dpp v52, v52, v52 row_ror:1 row_mask:0xf bank_mask:0xf
  v_add_f32_dpp v53, v53, v53 row_ror:1 row_mask:0xf bank_mask:0xf
  s_nop 0
  v_add_f32_dpp v52, v52, v52 row_ror:2 row_mask:0xf bank_mask:0xf
  v_add_f32_dpp v53, v53, v53 row_ror:2 row_mask:0xf bank_mask:0xf
  s_nop 0
  v_add_f32_dpp v52, v52, v52 row_ror:4 row_mask:0xf bank_mask:0xf
  v_add_f32_dpp v53, v53, v53 row_ror:4 row_mask:0xf bank_mask:0xf
  s_nop 0
  v_add_f32_dpp v52, v52, v52 row_ror:8 row_mask:0xf bank_mask:0xf
  v_add_f32_dpp v53, v53, v53 row_ror:8 row_mask:0xf bank_mask:0xf
  v_mov_b32 v54, v52
  v_mov_b32 v55, v53
  s_nop 0
  v_permlane16_swap_b32 v52, v54
  v_permlane16_swap_b32 v53, v55
  v_add_f32 v52, v52, v54
  v_add_f32 v53, v53, v55
  v_mul_f32 v52, 0x3b000000, v52
  v_mul_f32 v54, 0x3b000000, v53
  v_fma_f32 v54, -v52, v52, v54
  v_max_f32 v54, 0, v54
  v_add_f32 v54, 0x3727c5ac, v54
  v_rsq_f32 v15, v54
  s_nop 0
  v_mul_f32 v15, 0x3e0293ee, v15
  v_mul_f32 v14, -v52, v15
  v_lshlrev_b32 v40, 16, v232
  v_and_b32 v41, 0xffff0000, v232
  v_lshlrev_b32 v42, 16, v233
  v_and_b32 v43, 0xffff0000, v233
  v_lshlrev_b32 v44, 16, v234
  v_and_b32 v45, 0xffff0000, v234
  v_lshlrev_b32 v46, 16, v235
  v_and_b32 v47, 0xffff0000, v235
  v_mul_f32 v40, v40, v14
  v_mul_f32 v41, v41, v14
  v_mul_f32 v42, v42, v14
  v_mul_f32 v43, v43, v14
  v_mul_f32 v44, v44, v14
  v_mul_f32 v45, v45, v14
  v_mul_f32 v46, v46, v14
  v_mul_f32 v47, v47, v14
  s_sleep 1
  s_mov_b32 s58, 0
L_C_gpoll:
  buffer_load_dwordx4 v[16:19], v243, s[48:51], s94 offen sc1
  buffer_load_dwordx4 v[20:23], v243, s[48:51], s94 offen offset:256 sc1
  s_waitcnt vmcnt(1)
  v_mfma_f32_16x16x32_bf16 v[32:35], v[224:227], v[16:19], 0
  s_waitcnt vmcnt(0)
  v_mfma_f32_16x16x32_bf16 v[36:39], v[224:227], v[20:23], 0
  v_max_u32 v1, v16, v20
  v_cmp_eq_u32 vcc, -1, v1
  s_cbranch_vccz L_ok_24
  s_add_u32 s58, s58, 1
  s_cmp_lt_u32 s58, 200000
  s_cbranch_scc1 L_C_gpoll
L_ok_24:
L_C_gdone:
  s_nop 2
  v_fma_f32 v32, v32, v15, v40
  v_fma_f32 v33, v33, v15, v41
  v_fma_f32 v34, v34, v15, v42
  v_fma_f32 v35, v35, v15, v43
  v_fma_f32 v36, v36, v15, v44
  v_fma_f32 v37, v37, v15, v45
  v_fma_f32 v38, v38, v15, v46
  v_fma_f32 v39, v39, v15, v47
  v_cvt_pk_bf16_f32 v32, v32, v33
  v_cvt_pk_bf16_f32 v33, v34, v35
  v_cvt_pk_bf16_f32 v36, v36, v37
  v_cvt_pk_bf16_f32 v37, v38, v39
  s_mov_b32 exec_hi, 0
  ds_write_b64 v250, v[32:33]
  ds_write_b64 v250, v[36:37] offset:256
  s_mov_b32 exec_hi, -1
  s_waitcnt lgkmcnt(0)
  s_cmp_eq_u32 s55, 0
  s_cbranch_scc1 L_C_l0sync
  s_barrier
  s_barrier
  s_barrier
  s_branch L_C_nowo
L_C_l0sync:
  v_mov_b32 v1, 10520
  v_mov_b32 v2, 1
  s_mov_b64 exec, 1
  ds_add_u32 v1, v2
  s_mov_b64 exec, -1
  s_mov_b32 s58, 0
  v_mov_b32 v1, 10512
L_spcmode_25:
  ds_read_b32 v2, v1
  s_add_u32 s58, s58, 1
  s_waitcnt lgkmcnt(0)
  v_readfirstlane_b32 s57, v2
  s_cmp_gt_u32 s58, 200000
  s_cbranch_scc1 L_spdcmode_26
  s_cmp_lt_u32 s57, 1
  s_cbranch_scc1 L_spcmode_25
L_spdcmode_26:
  s_mov_b32 s56, s57
  s_cmp_lg_u32 s57, 2
  s_cbranch_scc1 L_C_g0nr2
  s_cmp_lg_u32 s96, 0
  s_cbranch_scc1 L_C_g0nr2
  buffer_store_dwordx4 v[4:7], v13, s[48:51], s97 offen sc1
  s_mov_b32 exec_lo, 0x01010101
  s_mov_b32 exec_hi, 0x01010101
  buffer_store_dwordx4 v[8:11], v3, s[48:51], s97 offen sc1
  s_mov_b64 exec, -1
  s_mov_b32 s96, 1
L_C_g0nr2:
  s_mov_b32 s58, 0
  v_mov_b32 v1, 10500
L_spwo_27:
  ds_read_b32 v2, v1
  s_add_u32 s58, s58, 1
  s_waitcnt lgkmcnt(0)
  v_readfirstlane_b32 s57, v2
  s_cmp_gt_u32 s58, 200000
  s_cbranch_scc1 L_spdwo_28
  s_cmp_lt_u32 s57, 1
  s_cbranch_scc1 L_spwo_27
L_spdwo_28:
  v_add_u32 v15, 28672, v251
  ds_read_b64_tr_b16 v[96:97], v15 offset:0
  ds_read_b64_tr_b16 v[98:99], v15 offset:512
  ds_read_b64_tr_b16 v[100:101], v15 offset:4096
  ds_read_b64_tr_b16 v[102:103], v15 offset:4608
  ds_read_b64_tr_b16 v[104:105], v15 offset:8192
  ds_read_b64_tr_b16 v[106:107], v15 offset:8704
  ds_read_b64_tr_b16 v[108:109], v15 offset:12288
  ds_read_b64_tr_b16 v[110:111], v15 offset:12800
  ds_read_b64_tr_b16 v[112:113], v15 offset:32
  ds_read_b64_tr_b16 v[114:115], v15 offset:544
  ds_read_b64_tr_b16 v[116:117], v15 offset:4128
  ds_read_b64_tr_b16 v[118:119], v15 offset:4640
  ds_read_b64_tr_b16 v[120:121], v15 offset:8224
  ds_read_b64_tr_b16 v[122:123], v15 offset:8736
  ds_read_b64_tr_b16 v[124:125], v15 offset:12320
  ds_read_b64_tr_b16 v[126:127], v15 offset:12832
  s_mov_b32 s58, 0
  v_mov_b32 v1, 10528
L_spap_29:
  ds_read_b32 v2, v1
  s_add_u32 s58, s58, 1
  s_waitcnt lgkmcnt(0)
  v_readfirstlane_b32 s57, v2
  s_cmp_gt_u32 s58, 200000
  s_cbranch_scc1 L_spdap_30
  s_cmp_lt_u32 s57, 4
  s_cbranch_scc1 L_spap_29
L_spdap_30:
L_C_nowo:
  s_lshl_b32 s94, s55, 15
  s_add_u32 s93, s94, 4096
  s_lshl_b32 s95, s55, 10
  s_mov_b32 s58, 0
  s_sleep 7
  buffer_load_dwordx4 v[48:51], v253, s[48:51], s95 offen
  buffer_load_dwordx4 v[52:55], v253, s[48:51], s95 offen offset:128
  buffer_load_dwordx4 v[16:19], v252, s[48:51], s94 offen offset:0
  buffer_load_dwordx4 v[20:23], v252, s[48:51], s93 offen offset:0
  buffer_load_dwordx4 v[24:27], v252, s[48:51], s94 offen offset:1024
  buffer_load_dwordx4 v[28:31], v252, s[48:51], s93 offen offset:1024
  buffer_load_dwordx4 v[32:35], v252, s[48:51], s94 offen offset:2048
  buffer_load_dwordx4 v[36:39], v252, s[48:51], s93 offen offset:2048
  buffer_load_dwordx4 v[40:43], v252, s[48:51], s94 offen offset:3072
  buffer_load_dwordx4 v[44:47], v252, s[48:51], s93 offen offset:3072
  s_branch L_C_ogo
L_C_opoll:
  buffer_load_dwordx4 v[48:51], v253, s[48:51], s95 offen sc1
  buffer_load_dwordx4 v[52:55], v253, s[48:51], s95 offen offset:128 sc1
  buffer_load_dwordx4 v[16:19], v252, s[48:51], s94 offen offset:0 sc1
  buffer_load_dwordx4 v[20:23], v252, s[48:51], s93 offen offset:0 sc1
  buffer_load_dwordx4 v[24:27], v252, s[48:51], s94 offen offset:1024 sc1
  buffer_load_dwordx4 v[28:31], v252, s[48:51], s93 offen offset:1024 sc1
  buffer_load_dwordx4 v[32:35], v252, s[48:51], s94 offen offset:2048 sc1
  buffer_load_dwordx4 v[36:39], v252, s[48:51], s93 offen offset:2048 sc1
  buffer_load_dwordx4 v[40:43], v252, s[48:51], s94 offen offset:3072 sc1
  buffer_load_dwordx4 v[44:47], v252, s[48:51], s93 offen offset:3072 sc1
L_C_ogo:
  s_waitcnt vmcnt(8)
  v_max3_f32 v56, v48, v50, v52
  v_max3_u32 v1, v48, v50, v52
  v_max_f32 v56, v56, v54
  v_max_u32 v1, v1, v54
  v_sub_f32 v57, v48, v56
  v_sub_f32 v58, v50, v56
  v_sub_f32 v59, v52, v56
  v_sub_f32 v60, v54, v56
  v_exp_f32 v57, v57
  v_exp_f32 v58, v58
  v_exp_f32 v59, v59
  v_exp_f32 v60, v60
  s_waitcnt vmcnt(7)
  v_mfma_f32_16x16x32_bf16 v[208:211], v[96:99], v[16:19], 0
  v_mul_f32 v57, v57, v49
  v_mfma_f32_16x16x32_bf16 v[216:219], v[112:115], v[16:19], 0
  v_mul_f32 v58, v58, v51
  s_waitcnt vmcnt(6)
  v_mfma_f32_16x16x32_bf16 v[212:215], v[96:99], v[20:23], 0
  v_mul_f32 v59, v59, v53
  v_mfma_f32_16x16x32_bf16 v[220:223], v[112:115], v[20:23], 0
  v_mul_f32 v60, v60, v55
  v_max3_u32 v1, v1, v16, v20
  s_waitcnt vmcnt(5)
  v_mfma_f32_16x16x32_bf16 v[208:211], v[100:103], v[24:27], v[208:211]
  v_add_f32 v61, v57, v58
  v_mfma_f32_16x16x32_bf16 v[216:219], v[116:119], v[24:27], v[216:219]
  v_add_f32 v62, v59, v60
  s_waitcnt vmcnt(4)
  v_mfma_f32_16x16x32_bf16 v[212:215], v[100:103], v[28:31], v[212:215]
  v_cndmask_b32 v57, v57, v58, s[100:101]
  v_mfma_f32_16x16x32_bf16 v[220:223], v[116:119], v[28:31], v[220:223]
  v_add_f32 v61, v61, v62
  v_max3_u32 v1, v1, v24, v28
  s_waitcnt vmcnt(3)
  v_mfma_f32_16x16x32_bf16 v[208:211], v[104:107], v[32:35], v[208:211]
  v_cndmask_b32 v59, v59, v60, s[100:101]
  v_mfma_f32_16x16x32_bf16 v[216:219], v[120:123], v[32:35], v[216:219]
  v_rcp_f32 v61, v61
  s_waitcnt vmcnt(2)
  v_mfma_f32_16x16x32_bf16 v[212:215], v[104:107], v[36:39], v[212:215]
  v_mfma_f32_16x16x32_bf16 v[220:223], v[120:123], v[36:39], v[220:223]
  v_mul_f32 v57, v57, v61
  v_max3_u32 v1, v1, v32, v36
  s_waitcnt vmcnt(1)
  v_mfma_f32_16x16x32_bf16 v[208:211], v[108:111], v[40:43], v[208:211]
  v_mul_f32 v59, v59, v61
  v_mfma_f32_16x16x32_bf16 v[216:219], v[124:127], v[40:43], v[216:219]
  s_waitcnt vmcnt(0)
  v_mfma_f32_16x16x32_bf16 v[212:215], v[108:111], v[44:47], v[212:215]
  v_mfma_f32_16x16x32_bf16 v[220:223], v[124:127], v[44:47], v[220:223]
  v_max3_u32 v1, v1, v40, v44
  v_cmp_eq_u32 vcc, -1, v1
  s_cbranch_vccz L_ok_31
  s_add_u32 s58, s58, 1
  s_cmp_lt_u32 s58, 200000
  s_cbranch_scc1 L_C_opoll
L_ok_31:
  v_mul_f32 v16, v208, v57
  v_mul_f32 v17, v209, v57
  v_mul_f32 v18, v210, v57
  v_mul_f32 v19, v211, v57
  v_mul_f32 v20, v216, v57
  v_mul_f32 v21, v217, v57
  v_mul_f32 v22, v218, v57
  v_mul_f32 v23, v219, v57
  v_fmac_f32 v16, v212, v59
  v_fmac_f32 v17, v213, v59
  v_fmac_f32 v18, v214, v59
  v_fmac_f32 v19, v215, v59
  v_fmac_f32 v20, v220, v59
  v_fmac_f32 v21, v221, v59
  v_fmac_f32 v22, v222, v59
  v_fmac_f32 v23, v223, v59
  v_add_f32_dpp v8, v16, v16 row_ror:8 row_mask:0xf bank_mask:0x3
  v_add_f32_dpp v9, v17, v17 row_ror:8 row_mask:0xf bank_mask:0x3
  v_add_f32_dpp v10, v18, v18 row_ror:8 row_mask:0xf bank_mask:0x3
  v_add_f32_dpp v11, v19, v19 row_ror:8 row_mask:0xf bank_mask:0x3
  v_add_f32_dpp v8, v20, v20 row_ror:8 row_mask:0xf bank_mask:0xc
  v_add_f32_dpp v9, v21, v21 row_ror:8 row_mask:0xf bank_mask:0xc
  v_add_f32_dpp v10, v22, v22 row_ror:8 row_mask:0xf bank_mask:0xc
  v_add_f32_dpp v11, v23, v23 row_ror:8 row_mask:0xf bank_mask:0xc
  v_cvt_pk_bf16_f32 v8, v8, v9
  v_cvt_pk_bf16_f32 v9, v10, v11
  v_mov_b32 v10, v8
  v_mov_b32 v11, v9
  s_nop 0
  v_permlane16_swap_b32 v8, v10
  v_permlane16_swap_b32 v9, v11
  s_cmp_lg_u32 s55, 0
  s_cbranch_scc1 L_C_noi2
  s_mov_b32 s58, 0
  v_mov_b32 v1, 10536
L_spci2_32:
  ds_read_b32 v2, v1
  s_add_u32 s58, s58, 1
  s_waitcnt lgkmcnt(0)
  v_readfirstlane_b32 s57, v2
  s_cmp_gt_u32 s58, 200000
  s_cbranch_scc1 L_spdci2_33
  s_cmp_lt_u32 s57, 1
  s_cbranch_scc1 L_spci2_32
L_spdci2_33:
L_C_noi2:
  s_lshl_b32 s94, s55, 18
  s_add_u32 s94, s94, 1310720
  s_mov_b32 exec_lo, 0x0000ffff
  s_mov_b32 exec_hi, 0x0000ffff
  buffer_store_dwordx4 v[8:11], v249, s[48:51], s94 offen sc1
  s_mov_b64 exec, -1
  s_cmp_lg_u32 s55, 0
  s_cbranch_scc1 L_C_now
  s_mov_b32 s98, 0
  s_mov_b32 s99, 0
  v_mov_b32 v1, 10504
  ds_read_b32 v2, v1
  s_waitcnt lgkmcnt(0)
  v_readfirstlane_b32 s57, v2
  s_nop 0
  s_cmp_eq_u32 s57, 0
  s_cbranch_scc1 L_C_ret0w
L_C_fetch:
  v_lshrrev_b32 v15, 7, v251
  v_lshlrev_b32 v15, 6, v15
  v_and_b32 v14, 0x18, v251
  v_add_u32 v15, v15, v14
  s_lshl_b32 s57, s60, 5
  s_add_u32 s57, s57, 61440
  v_add_u32 v15, s57, v15
  ds_read_b64_tr_b16 v[128:129], v15 offset:0
  ds_read_b64_tr_b16 v[130:131], v15 offset:256
  ds_read_b64_tr_b16 v[132:133], v15 offset:2048
  ds_read_b64_tr_b16 v[134:135], v15 offset:2304
  ds_read_b64_tr_b16 v[136:137], v15 offset:4096
  ds_read_b64_tr_b16 v[138:139], v15 offset:4352
  ds_read_b64_tr_b16 v[140:141], v15 offset:6144
  ds_read_b64_tr_b16 v[142:143], v15 offset:6400
  s_cmp_lg_u32 s60, 0
  s_cbranch_scc1 L_C_now1
  v_lshrrev_b32 v14, 7, v251
  v_lshlrev_b32 v14, 5, v14
  v_and_b32 v15, 0x18, v251
  v_add_u32 v14, v14, v15
  v_add_u32 v14, 45056, v14
  ds_read_b64_tr_b16 v[144:145], v14 offset:0
  ds_read_b64_tr_b16 v[146:147], v14 offset:128
  ds_read_b64_tr_b16 v[148:149], v14 offset:1024
  ds_read_b64_tr_b16 v[150:151], v14 offset:1152
  ds_read_b64_tr_b16 v[152:153], v14 offset:2048
  ds_read_b64_tr_b16 v[154:155], v14 offset:2176
  ds_read_b64_tr_b16 v[156:157], v14 offset:3072
  ds_read_b64_tr_b16 v[158:159], v14 offset:3200
  ds_read_b64_tr_b16 v[160:161], v14 offset:4096
  ds_read_b64_tr_b16 v[162:163], v14 offset:4224
  ds_read_b64_tr_b16 v[164:165], v14 offset:5120
  ds_read_b64_tr_b16 v[166:167], v14 offset:5248
  ds_read_b64_tr_b16 v[168:169], v14 offset:6144
  ds_read_b64_tr_b16 v[170:171], v14 offset:6272
  ds_read_b64_tr_b16 v[172:173], v14 offset:7168
  ds_read_b64_tr_b16 v[174:175], v14 offset:7296
  ds_read_b64_tr_b16 v[176:177], v14 offset:8192
  ds_read_b64_tr_b16 v[178:179], v14 offset:8320
  ds_read_b64_tr_b16 v[180:181], v14 offset:9216
  ds_read_b64_tr_b16 v[182:183], v14 offset:9344
  ds_read_b64_tr_b16 v[184:185], v14 offset:10240
  ds_read_b64_tr_b16 v[186:187], v14 offset:10368
  ds_read_b64_tr_b16 v[188:189], v14 offset:11264
  ds_read_b64_tr_b16 v[190:191], v14 offset:11392
  ds_read_b64_tr_b16 v[192:193], v14 offset:12288
  ds_read_b64_tr_b16 v[194:195], v14 offset:12416
  ds_read_b64_tr_b16 v[196:197], v14 offset:13312
  ds_read_b64_tr_b16 v[198:199], v14 offset:13440
  ds_read_b64_tr_b16 v[200:201], v14 offset:14336
  ds_read_b64_tr_b16 v[202:203], v14 offset:14464
  ds_read_b64_tr_b16 v[204:205], v14 offset:15360
  ds_read_b64_tr_b16 v[206:207], v14 offset:15488
  v_mov_b32 v8, 0x3f803f80
  v_mov_b32 v9, 0x3f803f80
  v_mov_b32 v10, 0x3f803f80
  v_mov_b32 v11, 0x3f803f80
  s_waitcnt lgkmcnt(0)
  s_nop 0
  v_mfma_f32_16x16x32_bf16 v[56:59], v[144:147], v[8:11], 0
  v_mfma_f32_16x16x32_bf16 v[60:63], v[148:151], v[8:11], 0
  v_mfma_f32_16x16x32_bf16 v[56:59], v[152:155], v[8:11], v[56:59]
  v_mfma_f32_16x16x32_bf16 v[60:63], v[156:159], v[8:11], v[60:63]
  v_mfma_f32_16x16x32_bf16 v[56:59], v[160:163], v[8:11], v[56:59]
  v_mfma_f32_16x16x32_bf16 v[60:63], v[164:167], v[8:11], v[60:63]
  v_mfma_f32_16x16x32_bf16 v[56:59], v[168:171], v[8:11], v[56:59]
  v_mfma_f32_16x16x32_bf16 v[60:63], v[172:175], v[8:11], v[60:63]
  v_mfma_f32_16x16x32_bf16 v[56:59], v[176:179], v[8:11], v[56:59]
  v_mfma_f32_16x16x32_bf16 v[60:63], v[180:183], v[8:11], v[60:63]
  v_mfma_f32_16x16x32_bf16 v[56:59], v[184:187], v[8:11], v[56:59]
  v_mfma_f32_16x16x32_bf16 v[60:63], v[188:191], v[8:11], v[60:63]
  v_mfma_f32_16x16x32_bf16 v[56:59], v[192:195], v[8:11], v[56:59]
  v_mfma_f32_16x16x32_bf16 v[60:63], v[196:199], v[8:11], v[60:63]
  v_mfma_f32_16x16x32_bf16 v[56:59], v[200:203], v[8:11], v[56:59]
  v_mfma_f32_16x16x32_bf16 v[60:63], v[204:207], v[8:11], v[60:63]
  s_nop 7
  v_add_f32_dpp v236, v60, v56 row_ror:8 row_mask:0xf bank_mask:0x3
  v_add_f32_dpp v237, v61, v57 row_ror:8 row_mask:0xf bank_mask:0x3
  v_add_f32_dpp v236, v58, v62 row_ror:8 row_mask:0xf bank_mask:0xc
  v_add_f32_dpp v237, v59, v63 row_ror:8 row_mask:0xf bank_mask:0xc
L_C_now1:
  s_waitcnt lgkmcnt(0)
  s_mov_b32 s99, 1
  s_cmp_eq_u32 s98, 1
  s_cbranch_scc1 L_C_ret1
  s_sleep 5
  s_branch L_C_ret0
L_C_ret0w:
  s_sleep 13
L_C_ret0:
  s_mov_b32 s58, 0
  v_mov_b32 v1, 10540
L_spxok_34:
  ds_read_b32 v2, v1
  s_add_u32 s58, s58, 1
  s_waitcnt lgkmcnt(0)
  v_readfirstlane_b32 s57, v2
  s_cmp_gt_u32 s58, 200000
  s_cbranch_scc1 L_spdxok_35
  s_cmp_lt_u32 s57, 1
  s_cbranch_scc1 L_spxok_34
L_spdxok_35:
  s_branch L_C_now2
L_C_now:
  s_sleep 13
L_C_now2:
  s_lshl_b32 s90, s55, 18
  s_add_u32 s90, s90, 1310720
  s_add_u32 s91, s90, 4096
  s_lshl_b32 s92, s55, 1
  s_add_u32 s92, s92, 0
  s_lshl_b32 s93, s92, 11
  s_add_u32 s93, s93, s3
  s_add_u32 s93, s93, 24576
  s_lshl_b32 s92, s92, 13
  s_add_u32 s92, s92, s3
  s_mov_b32 s58, 0
L_C_fa:
  buffer_load_dwordx4 v[16:19], v244, s[48:51], s90 offen offset:0 sc1
  buffer_load_dwordx4 v[20:23], v244, s[48:51], s90 offen offset:2048 sc1
  buffer_load_dwordx4 v[24:27], v244, s[48:51], s91 offen offset:0 sc1
  buffer_load_dwordx4 v[28:31], v244, s[48:51], s91 offen offset:2048 sc1
  s_waitcnt vmcnt(3)
  v_mfma_f32_16x16x32_bf16 v[56:59], v[224:227], v[16:19], 0
  s_waitcnt vmcnt(2)
  v_mfma_f32_16x16x32_bf16 v[56:59], v[224:227], v[20:23], v[56:59]
  v_max_u32 v1, v16, v20
  s_waitcnt vmcnt(1)
  v_mfma_f32_16x16x32_bf16 v[56:59], v[224:227], v[24:27], v[56:59]
  s_waitcnt vmcnt(0)
  v_mfma_f32_16x16x32_bf16 v[56:59], v[224:227], v[28:31], v[56:59]
  v_max3_u32 v1, v1, v24, v28
  v_cmp_eq_u32 vcc, -1, v1
  s_cbranch_vccz L_ok_36
  s_add_u32 s58, s58, 1
  s_cmp_lt_u32 s58, 200000
  s_cbranch_scc1 L_C_fa
L_ok_36:
  s_nop 4
  v_add_f32_dpp v56, v56, v56 row_ror:8 row_mask:0xf bank_mask:0xf
  v_add_f32_dpp v57, v57, v57 row_ror:8 row_mask:0xf bank_mask:0xf
  v_add_f32_dpp v58, v58, v58 row_ror:8 row_mask:0xf bank_mask:0xf
  v_add_f32_dpp v59, v59, v59 row_ror:8 row_mask:0xf bank_mask:0xf
  v_add_f32 v228, v228, v56
  v_add_f32 v229, v229, v57
  v_add_f32 v230, v230, v58
  v_add_f32 v231, v231, v59
  v_cvt_pk_bf16_f32 v8, v228, v229
  v_cvt_pk_bf16_f32 v9, v230, v231
  v_mov_b32 v10, v8
  v_mov_b32 v11, v9
  s_nop 0
  v_permlane16_swap_b32 v8, v10
  v_permlane16_swap_b32 v9, v11
  s_mov_b32 exec_lo, 0x000000ff
  s_mov_b32 exec_hi, 0
  s_cmp_eq_u32 s56, 1
  s_cbranch_scc1 L_pf_37
  buffer_store_dwordx4 v[8:11], v245, s[48:51], s92 offen sc1
  s_branch L_pd_38
L_pf_37:
  buffer_store_dwordx4 v[8:11], v245, s[48:51], s92 offen
L_pd_38:
  s_nop 1
  s_mov_b32 exec_lo, -1
  v_mul_f32 v11, v228, v228
  v_add_f32 v10, v228, v229
  v_fmac_f32 v11, v229, v229
  v_add_f32 v12, v230, v231
  v_fmac_f32 v11, v230, v230
  v_add_f32 v10, v10, v12
  v_fmac_f32 v11, v231, v231
  s_nop 0
  v_add_f32_dpp v10, v10, v10 quad_perm:[1,0,3,2] row_mask:0xf bank_mask:0xf
  v_add_f32_dpp v11, v11, v11 quad_perm:[1,0,3,2] row_mask:0xf bank_mask:0xf
  v_mov_b32 v12, v10
  v_mov_b32 v13, v11
  s_nop 0
  v_permlane16_swap_b32 v10, v12
  v_permlane16_swap_b32 v11, v13
  v_add_f32 v10, v10, v12
  v_add_f32 v11, v11, v13
  s_mov_b32 exec_lo, 0x55
  s_cmp_eq_u32 s56, 1
  s_cbranch_scc1 L_pf_39
  buffer_store_dwordx2 v[10:11], v246, s[48:51], s93 offen sc1
  s_branch L_pd_40
L_pf_39:
  buffer_store_dwordx2 v[10:11], v246, s[48:51], s93 offen
L_pd_40:
  s_mov_b64 exec, -1
  s_cmp_lg_u32 s55, 0
  s_cbranch_scc1 L_C_ret1
  s_cmp_eq_u32 s99, 1
  s_cbranch_scc1 L_C_ret1
  s_mov_b32 s58, 0
  v_mov_b32 v1, 10504
L_spw12b_41:
  ds_read_b32 v2, v1
  s_add_u32 s58, s58, 1
  s_waitcnt lgkmcnt(0)
  v_readfirstlane_b32 s57, v2
  s_cmp_gt_u32 s58, 200000
  s_cbranch_scc1 L_spdw12b_42
  s_cmp_lt_u32 s57, 1
  s_cbranch_scc1 L_spw12b_41
L_spdw12b_42:
  s_mov_b32 s98, 1
  s_branch L_C_fetch
L_C_ret1:
  s_cmp_lg_u32 s60, 0
  s_cbranch_scc1 L_C_skipf1
  s_cmp_ge_u32 s53, 14
  s_cbranch_scc1 L_C_skipf1
  s_lshl_b32 s91, s55, 12
  s_add_u32 s91, s91, s3
  s_add_u32 s91, s91, 24576
  s_lshl_b32 s90, s55, 14
  s_add_u32 s90, s90, s3
  s_add_u32 s92, s90, 4096
  s_mov_b32 s59, 0
  s_mov_b32 s58, 0
  s_sleep 4
L_C_1pre:
  buffer_load_dwordx4 v[48:51], v241, s[48:51], s91 offen sc1
  buffer_load_dwordx4 v[52:55], v241, s[48:51], s91 offen offset:1024 sc1
  s_waitcnt vmcnt(0)
  v_max3_u32 v1, v48, v50, v52
  v_max_u32 v1, v1, v54
  v_cmp_eq_u32 vcc, -1, v1
  s_cbranch_vccz L_ok_43
  s_add_u32 s58, s58, 1
  s_cmp_lt_u32 s58, 200000
  s_cbranch_scc1 L_C_1pre
L_ok_43:
L_C_1poll:
  buffer_load_dwordx4 v[16:19], v240, s[48:51], s90 offen offset:0 sc1
  buffer_load_dwordx4 v[20:23], v240, s[48:51], s90 offen offset:1024 sc1
  buffer_load_dwordx4 v[24:27], v240, s[48:51], s90 offen offset:2048 sc1
  buffer_load_dwordx4 v[28:31], v240, s[48:51], s90 offen offset:3072 sc1
  buffer_load_dwordx4 v[32:35], v240, s[48:51], s92 offen offset:0 sc1
  buffer_load_dwordx4 v[36:39], v240, s[48:51], s92 offen offset:1024 sc1
  buffer_load_dwordx4 v[40:43], v240, s[48:51], s92 offen offset:2048 sc1
  buffer_load_dwordx4 v[44:47], v240, s[48:51], s92 offen offset:3072 sc1
  s_cmp_lg_u32 s59, 0
  s_cbranch_scc1 L_C_1nost
  s_mov_b32 s59, 1
  v_pk_add_f32 v[48:49], v[48:49], v[50:51]
  v_pk_add_f32 v[52:53], v[52:53], v[54:55]
  v_pk_add_f32 v[48:49], v[48:49], v[52:53]
  s_nop 1
  v_add_f32_dpp v48, v48, v48 row_ror:8 row_mask:0xf bank_mask:0xf
  v_add_f32_dpp v49, v49, v49 row_ror:8 row_mask:0xf bank_mask:0xf
  v_mov_b32 v50, v48
  v_mov_b32 v51, v49
  s_nop 0
  v_permlane16_swap_b32 v48, v50
  v_permlane16_swap_b32 v49, v51
  v_pk_add_f32 v[48:49], v[48:49], v[50:51]
  v_mov_b32 v50, v48
  v_mov_b32 v51, v49
  s_nop 0
  v_permlane32_swap_b32 v48, v50
  v_permlane32_swap_b32 v49, v51
  v_pk_add_f32 v[48:49], v[48:49], v[50:51]
  v_mul_f32 v52, 0x3b000000, v48
  v_mul_f32 v50, 0x3b000000, v49
  v_fma_f32 v50, -v52, v52, v50
  v_max_f32 v50, 0, v50
  v_add_f32 v50, 0x3727c5ac, v50
  v_rsq_f32 v53, v50
  v_mul_f32 v12, 0x3fb8aa3b, v238
  v_mul_f32 v13, 0x3fb8aa3b, v239
  v_mul_f32 v54, 0x3fb8aa3b, v53
L_C_1nost:
  s_waitcnt vmcnt(7)
  v_mfma_f32_16x16x32_bf16 v[56:59], v[144:147], v[16:19], 0
  v_mfma_f32_16x16x32_bf16 v[60:63], v[148:151], v[16:19], 0
  s_waitcnt vmcnt(6)
  v_mfma_f32_16x16x32_bf16 v[56:59], v[152:155], v[20:23], v[56:59]
  v_mfma_f32_16x16x32_bf16 v[60:63], v[156:159], v[20:23], v[60:63]
  v_max_u32 v1, v16, v20
  s_waitcnt vmcnt(5)
  v_mfma_f32_16x16x32_bf16 v[56:59], v[160:163], v[24:27], v[56:59]
  v_mfma_f32_16x16x32_bf16 v[60:63], v[164:167], v[24:27], v[60:63]
  s_waitcnt vmcnt(4)
  v_mfma_f32_16x16x32_bf16 v[56:59], v[168:171], v[28:31], v[56:59]
  v_mfma_f32_16x16x32_bf16 v[60:63], v[172:175], v[28:31], v[60:63]
  v_max3_u32 v1, v1, v24, v28
  s_waitcnt vmcnt(3)
  v_mfma_f32_16x16x32_bf16 v[56:59], v[176:179], v[32:35], v[56:59]
  v_mfma_f32_16x16x32_bf16 v[60:63], v[180:183], v[32:35], v[60:63]
  s_waitcnt vmcnt(2)
  v_mfma_f32_16x16x32_bf16 v[56:59], v[184:187], v[36:39], v[56:59]
  v_mfma_f32_16x16x32_bf16 v[60:63], v[188:191], v[36:39], v[60:63]
  v_max3_u32 v1, v1, v32, v36
  s_waitcnt vmcnt(1)
  v_mfma_f32_16x16x32_bf16 v[56:59], v[192:195], v[40:43], v[56:59]
  v_mfma_f32_16x16x32_bf16 v[60:63], v[196:199], v[40:43], v[60:63]
  s_waitcnt vmcnt(0)
  v_mfma_f32_16x16x32_bf16 v[56:59], v[200:203], v[44:47], v[56:59]
  v_mfma_f32_16x16x32_bf16 v[60:63], v[204:207], v[44:47], v[60:63]
  v_max3_u32 v1, v1, v40, v44
  v_cmp_eq_u32 vcc, -1, v1
  s_cbranch_vccz L_ok_44
  s_add_u32 s58, s58, 1
  s_cmp_lt_u32 s58, 200000
  s_cbranch_scc1 L_C_1poll
L_ok_44:
  s_nop 4
  v_add_f32_dpp v8, v60, v56 row_ror:8 row_mask:0xf bank_mask:0x3
  v_add_f32_dpp v9, v61, v57 row_ror:8 row_mask:0xf bank_mask:0x3
  v_add_f32_dpp v8, v58, v62 row_ror:8 row_mask:0xf bank_mask:0xc
  v_add_f32_dpp v9, v59, v63 row_ror:8 row_mask:0xf bank_mask:0xc
  v_fma_f32 v8, -v52, v236, v8
  v_fma_f32 v9, -v52, v237, v9
  v_fma_f32 v10, v8, v54, v12
  v_fma_f32 v11, v9, v54, v13
  v_fma_f32 v8, v8, v53, v238
  v_min_f32 v10, 0x42640000, v10
  v_min_f32 v11, 0x42640000, v11
  v_fma_f32 v9, v9, v53, v239
  v_exp_f32 v10, v10
  v_exp_f32 v11, v11
  s_lshl_b32 s94, s55, 12
  v_add_f32 v12, 2.0, v10
  v_add_f32 v13, 2.0, v11
  v_mul_f32 v10, v10, v12
  v_mul_f32 v11, v11, v13
  v_add_f32 v12, 2.0, v10
  v_add_f32 v13, 2.0, v11
  v_mul_f32 v8, v8, v10
  v_rcp_f32 v12, v12
  v_rcp_f32 v13, v13
  v_mul_f32 v9, v9, v11
  v_mul_f32 v8, v8, v12
  v_mul_f32 v9, v9, v13
  v_cvt_pk_bf16_f32 v8, v8, v9
  s_cmp_eq_u32 s56, 1
  s_cbranch_scc1 L_pf_45
  buffer_store_dword v8, v247, s[48:51], s94 offen sc1
  s_branch L_pd_46
L_pf_45:
  buffer_store_dword v8, v247, s[48:51], s94 offen
L_pd_46:
  s_sleep 4
  s_branch L_C_nof1
L_C_skipf1:
  s_sleep 12
L_C_nof1:
  s_lshl_b32 s94, s55, 12
  v_subrev_u32 v2, 512, v248
  v_cmp_le_u32 vcc, 40, v0
  v_and_b32 v3, 8, v0
  v_cmp_ne_u32 s[94:95], 0, v3
  s_nop 0
  s_and_b64 vcc, vcc, s[94:95]
  v_cndmask_b32 v3, v248, v2, vcc
  s_lshl_b32 s93, s55, 18
  s_add_u32 s93, s93, 1835008
  s_lshr_b32 s95, s53, 1
  s_lshl_b32 s95, s95, 1
  s_add_u32 s95, s95, s60
  s_lshl_b32 s95, s95, 12
  s_add_u32 s93, s93, s95
  s_lshl_b32 s95, s52, 1
  s_and_b32 s57, s53, 1
  s_add_u32 s95, s95, s57
  s_lshl_b32 s95, s95, 8
  s_add_u32 s93, s93, s95
  v_and_b32 v12, 0xff, v249
  s_lshl_b32 s94, s55, 12
  s_mov_b32 s58, 0
L_C_2poll:
  buffer_load_dwordx4 v[56:59], v248, s[48:51], s94 offen sc1
  buffer_load_dwordx4 v[60:63], v3, s[48:51], s94 offen offset:1024 sc1
  s_waitcnt vmcnt(1)
  v_mfma_f32_16x16x32_bf16 v[16:19], v[128:131], v[56:59], 0
  v_mfma_f32_16x16x32_bf16 v[20:23], v[132:135], v[56:59], 0
  v_max3_u32 v1, v56, v57, v58
  v_max_u32 v1, v1, v59
  s_waitcnt vmcnt(0)
  v_mfma_f32_16x16x32_bf16 v[16:19], v[136:139], v[60:63], v[16:19]
  v_mfma_f32_16x16x32_bf16 v[20:23], v[140:143], v[60:63], v[20:23]
  v_max3_u32 v1, v1, v60, v61
  v_max3_u32 v1, v1, v62, v63
  v_cmp_eq_u32 vcc, -1, v1
  s_cbranch_vccz L_ok_47
  s_add_u32 s58, s58, 1
  s_cmp_lt_u32 s58, 200000
  s_cbranch_scc1 L_C_2poll
L_ok_47:
  s_nop 3
  v_add_f32_dpp v8, v20, v16 row_ror:8 row_mask:0xf bank_mask:0x3
  v_add_f32_dpp v9, v21, v17 row_ror:8 row_mask:0xf bank_mask:0x3
  v_add_f32_dpp v10, v22, v18 row_ror:8 row_mask:0xf bank_mask:0x3
  v_add_f32_dpp v11, v23, v19 row_ror:8 row_mask:0xf bank_mask:0x3
  v_cvt_pk_bf16_f32 v8, v8, v9
  v_cvt_pk_bf16_f32 v9, v10, v11
  v_mov_b32 v10, v8
  v_mov_b32 v11, v9
  s_nop 0
  v_permlane16_swap_b32 v8, v10
  v_permlane16_swap_b32 v9, v11
  s_mov_b32 exec_lo, 0x000000ff
  s_mov_b32 exec_hi, 0x000000ff
  buffer_store_dwordx4 v[8:11], v12, s[48:51], s93 offen sc1
  s_mov_b64 exec, -1
  s_lshl_b32 s90, s55, 18
  s_add_u32 s90, s90, 1835008
  s_add_u32 s91, s90, 4096
  s_lshl_b32 s92, s55, 1
  s_add_u32 s92, s92, 1
  s_lshl_b32 s93, s92, 11
  s_add_u32 s93, s93, s3
  s_add_u32 s93, s93, 24576
  s_lshl_b32 s92, s92, 13
  s_add_u32 s92, s92, s3
  s_mov_b32 s58, 0
  s_sleep 11
  s_lshl_b32 s91, s53, 12
  s_sub_u32 s90, s90, s91
L_C_fb:
  buffer_load_dwordx4 v[16:19], v244, s[48:51], s90 offen offset:0 sc1
  buffer_load_dwordx4 v[20:23], v244, s[48:51], s90 offen offset:2048 sc1
  s_waitcnt vmcnt(1)
  v_mfma_f32_16x16x32_bf16 v[56:59], v[224:227], v[16:19], 0
  s_waitcnt vmcnt(0)
  v_mfma_f32_16x16x32_bf16 v[56:59], v[224:227], v[20:23], v[56:59]
  v_max_u32 v1, v16, v20
  v_cmp_eq_u32 vcc, -1, v1
  s_cbranch_vccz L_ok_48
  s_add_u32 s58, s58, 1
  s_cmp_lt_u32 s58, 200000
  s_cbranch_scc1 L_C_fb
L_ok_48:
  s_nop 4
  v_add_f32_dpp v56, v56, v56 row_ror:8 row_mask:0xf bank_mask:0xf
  v_add_f32_dpp v57, v57, v57 row_ror:8 row_mask:0xf bank_mask:0xf
  v_add_f32_dpp v58, v58, v58 row_ror:8 row_mask:0xf bank_mask:0xf
  v_add_f32_dpp v59, v59, v59 row_ror:8 row_mask:0xf bank_mask:0xf
  v_add_f32 v228, v228, v56
  v_add_f32 v229, v229, v57
  v_add_f32 v230, v230, v58
  v_add_f32 v231, v231, v59
  v_cvt_pk_bf16_f32 v8, v228, v229
  v_cvt_pk_bf16_f32 v9, v230, v231
  s_cmp_eq_u32 s55, 1
  s_cbranch_scc1 L_C_final
  v_mov_b32 v10, v8
  v_mov_b32 v11, v9
  s_nop 0
  v_permlane16_swap_b32 v8, v10
  v_permlane16_swap_b32 v9, v11
  s_mov_b32 exec_lo, 0x000000ff
  s_mov_b32 exec_hi, 0
  s_cmp_eq_u32 s56, 1
  s_cbranch_scc1 L_pf_49
  buffer_store_dwordx4 v[8:11], v245, s[48:51], s92 offen sc1
  s_branch L_pd_50
L_pf_49:
  buffer_store_dwordx4 v[8:11], v245, s[48:51], s92 offen
L_pd_50:
  s_nop 1
  s_mov_b32 exec_lo, -1
  v_mul_f32 v11, v228, v228
  v_add_f32 v10, v228, v229
  v_fmac_f32 v11, v229, v229
  v_add_f32 v12, v230, v231
  v_fmac_f32 v11, v230, v230
  v_add_f32 v10, v10, v12
  v_fmac_f32 v11, v231, v231
  s_nop 0
  v_add_f32_dpp v10, v10, v10 quad_perm:[1,0,3,2] row_mask:0xf bank_mask:0xf
  v_add_f32_dpp v11, v11, v11 quad_perm:[1,0,3,2] row_mask:0xf bank_mask:0xf
  v_mov_b32 v12, v10
  v_mov_b32 v13, v11
  s_nop 0
  v_permlane16_swap_b32 v10, v12
  v_permlane16_swap_b32 v11, v13
  v_add_f32 v10, v10, v12
  v_add_f32 v11, v11, v13
  s_mov_b32 exec_lo, 0x55
  s_cmp_eq_u32 s56, 1
  s_cbranch_scc1 L_pf_51
  buffer_store_dwordx2 v[10:11], v246, s[48:51], s93 offen sc1
  s_branch L_pd_52
L_pf_51:
  buffer_store_dwordx2 v[10:11], v246, s[48:51], s93 offen
L_pd_52:
  s_mov_b64 exec, -1
  s_mov_b32 s55, 1
  s_branch L_C_loop
L_C_final:
  v_and_b32 v10, 7, v0
  v_lshrrev_b32 v10, 1, v10
  s_lshl_b32 s90, s60, 2
  v_add_u32 v10, s90, v10
  v_cmp_eq_u32 vcc, s52, v10
  s_mov_b32 exec_lo, 0x00ff00ff
  s_mov_b32 exec_hi, 0
  s_and_b64 exec, exec, vcc
  s_cbranch_execz L_C_nost
  buffer_store_dwordx2 v[8:9], v255, s[16:19], 0 offen
L_C_nost:
  s_mov_b64 exec, 1
  s_cmp_lg_u32 s2, 0
  s_cbranch_scc1 L_C_noep
  s_cmp_lg_u32 s60, 0
  s_cbranch_scc1 L_C_noep
  v_mov_b32 v10, s63
  v_mov_b32 v11, 3149824
  buffer_store_dword v10, v11, s[48:51], 0 offen
L_C_noep:
  s_mov_b64 exec, -1
L_end:
  s_endpgm
.section .rodata,"a"
.p2align 6
.amdhsa_kernel interleave_layers__sliding_block_cached__dense_activation_mish__decode_kernel
  .amdhsa_next_free_vgpr 256
  .amdhsa_next_free_sgpr 102
  .amdhsa_accum_offset 256
  .amdhsa_group_segment_fixed_size 0
  .amdhsa_kernarg_size 96
  .amdhsa_user_sgpr_count 2
  .amdhsa_user_sgpr_kernarg_segment_ptr 1
  .amdhsa_system_sgpr_workgroup_id_x 1
.end_amdhsa_kernel
```
